```python
import torch

def _softmax(x, axis=-1):
    return torch.softmax(x, dim=axis)
def _gelu(x):
    return torch.nn.functional.gelu(x, approximate="tanh")
def _silu(x):
    return torch.nn.functional.silu(x)
def _sigmoid(x):
    return torch.sigmoid(x)
def _layernorm(x, axis=-1, eps=1e-5):
    m = x.mean(dim=axis, keepdim=True)
    v = x.var(dim=axis, keepdim=True, unbiased=False)
    return (x - m) / torch.sqrt(v + eps)
def _scatter_add(tgt, idx, src, axis=0):
    return tgt.clone().index_add_(axis, idx, src)
def _segment_sum(src, seg, n):
    out = torch.zeros((n,) + src.shape[1:], dtype=src.dtype)
    return out.index_add_(0, seg, src)
def _pad(x, pw):
    flat = tuple(v for pair in reversed(pw) for v in pair)
    return torch.nn.functional.pad(x, flat)

kernel_name = 'gated_mix__spectral_gfnet__dense_activation_mish__prompt'

def setup_inputs():

    _w = (lambda a: (lambda t: t.to(torch.bfloat16) if t.is_floating_point() else t)(torch.as_tensor(a)))
    def _A_setup():
        B, S, D = 1, 2048, 448
        Df = D // 2 + 1
        return {
            "x": _w((lambda *s: torch.randn(*s, dtype=torch.bfloat16) * 0.05)(B, S, D)),
            "w_r": _w((lambda *s: torch.randn(*s, dtype=torch.bfloat16) * 1.6)(S, Df) * 0.02),
            "w_i": _w((lambda *s: torch.randn(*s, dtype=torch.bfloat16) * 1.6)(S, Df) * 0.02),
        }
    _A_in = _A_setup()

    def _B_setup():
        B, S, D, F = 1, 2048, 448, 1792
        return {
            "x": _w((lambda *s: torch.randn(*s, dtype=torch.bfloat16) * 0.05)(B, S, D)),
            "w1": _w((lambda *s: torch.randn(*s, dtype=torch.bfloat16) * 6.4)(D, F) * (D ** -0.5)),
            "b1": _w((lambda *s: torch.randn(*s, dtype=torch.bfloat16) * 0.05)(F)),
            "w2": _w((lambda *s: torch.randn(*s, dtype=torch.bfloat16) * 0.05)(F, D) * (F ** -0.5)),
        }
    _B_in = _B_setup()

    return {
        "A_x": _A_in["x"],
        "A_w_r": _A_in["w_r"],
        "A_w_i": _A_in["w_i"],
        "B_x": _B_in["x"],
        "B_w1": _B_in["w1"],
        "B_b1": _B_in["b1"],
        "B_w2": _B_in["w2"],
        "gate_w": _w((lambda *s: torch.randn(*s, dtype=torch.bfloat16) * 0.05)(448) * 16.0),
    }

def reference(A_x, A_w_r, A_w_i, B_x, B_w1, B_b1, B_w2, gate_w):
    def _A_ref(x, w_r, w_i):
        B, S, D = x.shape
        X = (lambda x, axes=(-2,-1): torch.fft.rfft2(x.float(), dim=axes))(x, axes=(-2, -1))
        W = w_r + 1j * w_i
        X = X * W
        y = (lambda x, s, axes=(-2,-1): torch.fft.irfft2(x, s=s, dim=axes).to(torch.bfloat16))(X, (S, D), axes=(-2, -1))
        return y

    def _B_ref(x, w1, b1, w2):
        h = torch.einsum("bsd,df->bsf", x, w1) + b1
        sp = torch.log1p(torch.exp(-torch.abs(h))) + torch.where(h > 0, h, torch.zeros_like(h))
        act = h * torch.tanh(sp)
        return torch.einsum("bsf,fd->bsd", act, w2)

    x = A_x
    g = _sigmoid((x * gate_w).sum(-1, keepdims=True))
    a = _A_ref(x, A_w_r, A_w_i)
    b = _B_ref(x, B_w1, B_b1, B_w2)
    return g * a + (1 - g) * b
```

```asm
; @launch grid=(256,1,1) block=(512,1,1) lds=163840
.amdgcn_target "amdgcn-amd-amdhsa--gfx950"
.text
.globl gated_mix__spectral_gfnet__dense_activation_mish__prompt_kernel
.p2align 8
.type gated_mix__spectral_gfnet__dense_activation_mish__prompt_kernel,@function
gated_mix__spectral_gfnet__dense_activation_mish__prompt_kernel:
    s_cmp_ge_u32 s2, 256
    s_cbranch_scc1 L_end
    s_load_dwordx2 s[16:17], s[0:1], 0
    s_load_dwordx2 s[20:21], s[0:1], 32
    s_load_dwordx2 s[28:29], s[0:1], 80
    s_load_dwordx2 s[24:25], s[0:1], 48
    s_getpc_b64 s[12:13]
L_pc:
    s_lshl_b32 s3, s2, 8
    s_and_b32 s3, s3, 0x7800
    v_lshl_add_u32 v6, v0, 2, s3
    v_min_u32 v6, L_end-L_pc, v6
    v_mov_b32 v13, s13
    v_add_co_u32 v12, vcc, s12, v6
    s_nop 1
    v_addc_co_u32 v13, vcc, 0, v13, vcc
    global_load_dword v15, v[12:13], off
    v_and_b32 v2, 63, v0
    v_lshrrev_b32 v5, 6, v0
    s_lshr_b32 s9, s2, 3
    s_and_b32 s50, s2, 7
    v_readfirstlane_b32 s15, v5
    v_lshrrev_b32 v3, 4, v2
    v_and_b32 v4, 15, v0
    s_lshr_b32 s44, s50, 2
    s_lshl_b32 s44, s44, 3
    s_lshr_b32 s5, s9, 2
    s_add_u32 s44, s44, s5
    s_and_b32 s8, s15, 3
    s_and_b32 s48, s50, 3
    s_and_b32 s49, s9, 3
    s_lshl_b32 s45, s48, 2
    s_add_u32 s45, s45, s49
    s_lshl_b32 s52, s44, 2
    s_add_u32 s46, s52, s8
    s_and_b32 s47, s45, 1
    s_lshl_b32 s51, s49, 1
    s_add_u32 s51, s51, s5
    s_sub_u32 s3, s51, 7
    s_min_u32 s51, s51, s3
    s_xor_b32 s49, s49, 0
    s_lshl_b32 s53, s8, 12
    s_mov_b32 s30, 0x1b69f00
    s_mov_b32 s31, 0x20000
    s_lshl_b32 s83, s51, 1
    s_add_u32 s83, s83, s8
    s_cmp_ge_u32 s15, 4
    s_cbranch_scc1 L_S
    s_load_dwordx2 s[32:33], s[0:1], 40
    s_load_dwordx2 s[36:37], s[0:1], 56
    s_load_dwordx2 s[40:41], s[0:1], 64
    s_mov_b32 s42, 0x1c0000
    s_mov_b32 s43, 0x20000
    s_mul_i32 s68, s46, 896
    s_mul_i32 s69, s45, 224
    s_mul_i32 s3, s8, 28672
    s_add_u32 s69, s69, s3
    s_mul_i32 s72, s8, 896
    s_lshl_b32 s4, s47, 1
    v_lshrrev_b32 v5, 3, v2
    v_mul_u32_u24 v5, 57344, v5
    v_and_b32 v6, 7, v2
    v_xor_b32 v6, v6, v3
    v_lshl_add_u32 v20, v6, 4, v5
    v_xor_b32 v21, 64, v20
    v_add_u32 v21, 458752, v21
    v_mul_u32_u24 v5, 4682, v2
    v_lshrrev_b32 v5, 16, v5
    v_mul_u32_u24 v6, 14, v5
    v_sub_u32 v6, v2, v6
    v_mul_u32_u24 v7, 896, v5
    v_lshl_add_u32 v23, v6, 4, v7
    v_add_u32 v6, s4, v6
    v_subrev_u32 v7, 14, v6
    v_min_u32 v6, v6, v7
    v_mul_u32_u24 v7, 3584, v5
    v_lshl_add_u32 v22, v6, 4, v7
    s_mov_b32 s18, 0x1c0000
    s_mov_b32 s19, 0x20000
    s_mov_b32 s22, 0x188000
    s_mov_b32 s23, 0x20000
    s_mov_b32 s26, 0x188000
    s_mov_b32 s27, 0x20000
    s_lshl_b32 s70, s51, 7
    s_add_u32 s70, s70, s68
    s_mul_i32 s71, s51, 229376
    s_add_u32 s71, s71, s69
    s_waitcnt lgkmcnt(0)
    s_load_dword s91, s[20:21], 0
    s_load_dword s91, s[16:17], 0
    s_load_dword s91, s[32:33], 0
    s_load_dword s91, s[24:25], 0
    s_add_u32 m0, s53, 0
    s_nop 0
    buffer_load_dwordx4 v20, s[16:19], s70 offen lds
    s_add_u32 m0, s53, 1024
    s_nop 0
    buffer_load_dwordx4 v21, s[16:19], s70 offen lds
    s_add_u32 m0, s72, 65536
    s_mov_b32 exec_hi, 0xffffff
    buffer_load_dwordx4 v22, s[20:23], s71 offen lds
    s_mov_b32 exec_hi, -1
    s_add_u32 s71, s71, 14336
    s_add_u32 m0, s72, 69120
    s_mov_b32 exec_hi, 0xffffff
    buffer_load_dwordx4 v22, s[20:23], s71 offen lds
    s_mov_b32 exec_hi, -1
    s_add_u32 s70, s70, 917504
    s_add_u32 m0, s53, 2048
    s_nop 0
    buffer_load_dwordx4 v20, s[16:19], s70 offen lds
    s_add_u32 m0, s53, 3072
    s_nop 0
    buffer_load_dwordx4 v21, s[16:19], s70 offen lds
    s_add_u32 s71, s71, 100352
    s_add_u32 m0, s72, 72704
    s_mov_b32 exec_hi, 0xffffff
    buffer_load_dwordx4 v22, s[20:23], s71 offen lds
    s_mov_b32 exec_hi, -1
    s_add_u32 s71, s71, 14336
    s_add_u32 m0, s72, 76288
    s_mov_b32 exec_hi, 0xffffff
    buffer_load_dwordx4 v22, s[20:23], s71 offen lds
    s_mov_b32 exec_hi, -1
    s_cmp_eq_u32 s45, 15
    s_cbranch_scc1 L_gw
L_nogw:
    s_add_u32 s51, s51, 1
    s_cmp_eq_u32 s51, 7
    s_cselect_b32 s51, 0, s51
    s_add_u32 s12, s28, 0x1910000
    s_addc_u32 s13, s29, 0
    s_load_dword s14, s[12:13], 0
    v_lshlrev_b32 v9, 4, v2
    v_mov_b32 v10, 0
    v_mov_b32 v17, 1
    v_lshlrev_b32 v18, 3, v3
    s_add_u32 s52, s52, s48
    s_mov_b32 s54, 0x3b124925
    s_mov_b32 s55, 0xc3e00000
    v_lshrrev_b32 v8, 1, v4
    v_xor_b32 v8, v8, v3
    v_lshlrev_b32 v8, 4, v8
    v_lshl_add_u32 v8, v4, 7, v8
    v_add_u32 v12, s53, v8
    v_xor_b32 v13, 64, v12
    v_and_b32 v16, 3, v2
    v_lshlrev_b32 v16, 2, v16
    v_add_u32 v16, 162816, v16
    s_lshl_b32 s56, s8, 2
    s_add_u32 s56, s56, 162816
    v_mov_b32 v19, s56
    s_mov_b32 s34, 3584
    s_mov_b32 s35, 0x20000
    s_mul_i32 s56, s45, 224
    s_mul_i32 s3, s47, 32
    s_add_u32 s56, s56, s3
    s_mul_i32 s57, s45, 224
    s_mul_i32 s3, s47, -192
    s_add_u32 s57, s57, s3
    s_add_u32 s57, s57, 0xc0
    s_cmp_eq_u32 s45, 15
    s_cbranch_scc1 L_nofgM
    v_lshl_add_u32 v78, s45, 4, v4
    v_mov_b32 v76, 1.0
    v_cmp_eq_u32 vcc, 0, v78
    s_nop 1
    v_cndmask_b32 v76, v76, 0.5, vcc
    v_cmp_eq_u32 vcc, 224, v78
    s_nop 1
    v_cndmask_b32 v76, v76, 0.5, vcc
    v_cmp_lt_u32 vcc, 224, v78
    s_nop 1
    v_cndmask_b32 v76, v76, 0, vcc
    v_cvt_f32_u32 v78, v78
    v_mul_f32 v79, s54, v78
    s_lshl_b32 s4, s8, 11
    s_add_u32 s4, s4, 122880
    v_add_u32 v81, s4, v9
    s_add_u32 s4, s83, 0
    s_sub_u32 s5, s4, 14
    s_min_u32 s4, s4, s5
    v_lshl_add_u32 v80, s4, 5, v18
    v_cvt_f32_u32 v80, v80
    v_mul_f32 v8, v78, v80
    v_mul_f32 v60, s54, v8
    v_floor_f32 v60, v60
    v_fma_f32 v8, v60, s55, v8
    v_mul_f32 v60, s54, v8
    v_add_f32 v61, v60, v79
    v_add_f32 v62, v61, v79
    v_add_f32 v63, v62, v79
    v_add_f32 v64, v63, v79
    v_add_f32 v65, v64, v79
    v_add_f32 v66, v65, v79
    v_add_f32 v67, v66, v79
    v_cos_f32 v44, v60
    v_sin_f32 v52, v60
    v_cos_f32 v45, v61
    v_sin_f32 v53, v61
    v_cos_f32 v46, v62
    v_sin_f32 v54, v62
    v_cos_f32 v47, v63
    v_sin_f32 v55, v63
    v_cos_f32 v48, v64
    v_sin_f32 v56, v64
    v_cos_f32 v49, v65
    v_sin_f32 v57, v65
    v_cos_f32 v50, v66
    v_sin_f32 v58, v66
    v_cos_f32 v51, v67
    v_sin_f32 v59, v67
    v_pk_mul_f32 v[44:45], v[44:45], v[76:77] op_sel_hi:[1,0]
    v_pk_mul_f32 v[52:53], v[52:53], v[76:77] op_sel_hi:[1,0]
    v_pk_mul_f32 v[46:47], v[46:47], v[76:77] op_sel_hi:[1,0]
    v_pk_mul_f32 v[54:55], v[54:55], v[76:77] op_sel_hi:[1,0]
    v_pk_mul_f32 v[48:49], v[48:49], v[76:77] op_sel_hi:[1,0]
    v_pk_mul_f32 v[56:57], v[56:57], v[76:77] op_sel_hi:[1,0]
    v_pk_mul_f32 v[50:51], v[50:51], v[76:77] op_sel_hi:[1,0]
    v_pk_mul_f32 v[58:59], v[58:59], v[76:77] op_sel_hi:[1,0]
    v_cvt_pk_bf16_f32 v68, v44, v45
    v_cvt_pk_bf16_f32 v72, -v52, -v53
    v_cvt_pk_bf16_f32 v69, v46, v47
    v_cvt_pk_bf16_f32 v73, -v54, -v55
    v_cvt_pk_bf16_f32 v70, v48, v49
    v_cvt_pk_bf16_f32 v74, -v56, -v57
    v_cvt_pk_bf16_f32 v71, v50, v51
    v_cvt_pk_bf16_f32 v75, -v58, -v59
    ds_write_b128 v81, v[68:71] offset:0
    ds_write_b128 v81, v[72:75] offset:1024
    s_add_u32 s4, s83, 4
    s_sub_u32 s5, s4, 14
    s_min_u32 s4, s4, s5
    v_lshl_add_u32 v80, s4, 5, v18
    v_cvt_f32_u32 v80, v80
    v_mul_f32 v8, v78, v80
    v_mul_f32 v60, s54, v8
    v_floor_f32 v60, v60
    v_fma_f32 v8, v60, s55, v8
    v_mul_f32 v60, s54, v8
    v_add_f32 v61, v60, v79
    v_add_f32 v62, v61, v79
    v_add_f32 v63, v62, v79
    v_add_f32 v64, v63, v79
    v_add_f32 v65, v64, v79
    v_add_f32 v66, v65, v79
    v_add_f32 v67, v66, v79
    v_cos_f32 v44, v60
    v_sin_f32 v52, v60
    v_cos_f32 v45, v61
    v_sin_f32 v53, v61
    v_cos_f32 v46, v62
    v_sin_f32 v54, v62
    v_cos_f32 v47, v63
    v_sin_f32 v55, v63
    v_cos_f32 v48, v64
    v_sin_f32 v56, v64
    v_cos_f32 v49, v65
    v_sin_f32 v57, v65
    v_cos_f32 v50, v66
    v_sin_f32 v58, v66
    v_cos_f32 v51, v67
    v_sin_f32 v59, v67
    v_pk_mul_f32 v[44:45], v[44:45], v[76:77] op_sel_hi:[1,0]
    v_pk_mul_f32 v[52:53], v[52:53], v[76:77] op_sel_hi:[1,0]
    v_pk_mul_f32 v[46:47], v[46:47], v[76:77] op_sel_hi:[1,0]
    v_pk_mul_f32 v[54:55], v[54:55], v[76:77] op_sel_hi:[1,0]
    v_pk_mul_f32 v[48:49], v[48:49], v[76:77] op_sel_hi:[1,0]
    v_pk_mul_f32 v[56:57], v[56:57], v[76:77] op_sel_hi:[1,0]
    v_pk_mul_f32 v[50:51], v[50:51], v[76:77] op_sel_hi:[1,0]
    v_pk_mul_f32 v[58:59], v[58:59], v[76:77] op_sel_hi:[1,0]
    v_cvt_pk_bf16_f32 v68, v44, v45
    v_cvt_pk_bf16_f32 v72, -v52, -v53
    v_cvt_pk_bf16_f32 v69, v46, v47
    v_cvt_pk_bf16_f32 v73, -v54, -v55
    v_cvt_pk_bf16_f32 v70, v48, v49
    v_cvt_pk_bf16_f32 v74, -v56, -v57
    v_cvt_pk_bf16_f32 v71, v50, v51
    v_cvt_pk_bf16_f32 v75, -v58, -v59
    ds_write_b128 v81, v[68:71] offset:8192
    ds_write_b128 v81, v[72:75] offset:9216
L_nofgM:
    buffer_load_dwordx2 v[28:29], v18, s[32:35], s56 offen offset:0
    buffer_load_dwordx2 v[30:31], v18, s[32:35], s56 offen offset:32
    buffer_load_dwordx2 v[32:33], v18, s[32:35], s56 offen offset:64
    buffer_load_dwordx2 v[34:35], v18, s[32:35], s56 offen offset:96
    buffer_load_dwordx2 v[36:37], v18, s[32:35], s56 offen offset:128
    buffer_load_dwordx2 v[38:39], v18, s[32:35], s56 offen offset:160
    buffer_load_dwordx2 v[40:41], v18, s[32:35], s57 offen offset:0
    s_and_b32 s82, s45, 3
    s_mul_i32 s73, s48, 401408
    s_mul_i32 s3, s8, 3584
    s_add_u32 s73, s73, s3
    s_mul_i32 s3, s49, 224
    s_add_u32 s73, s73, s3
    s_xor_b32 s3, s82, 0
    s_mul_i32 s3, s3, 7
    s_add_u32 s3, s3, 1
    s_lshr_b32 s3, s3, 1
    s_mul_i32 s3, s3, 28672
    s_add_u32 s74, s3, s73
    s_xor_b32 s3, s82, 1
    s_mul_i32 s3, s3, 7
    s_add_u32 s3, s3, 1
    s_lshr_b32 s3, s3, 1
    s_mul_i32 s3, s3, 28672
    s_add_u32 s75, s3, s73
    s_xor_b32 s3, s82, 2
    s_mul_i32 s3, s3, 7
    s_add_u32 s3, s3, 1
    s_lshr_b32 s3, s3, 1
    s_mul_i32 s3, s3, 28672
    s_add_u32 s76, s3, s73
    s_xor_b32 s3, s82, 3
    s_mul_i32 s3, s3, 7
    s_add_u32 s3, s3, 1
    s_lshr_b32 s3, s3, 1
    s_mul_i32 s3, s3, 28672
    s_add_u32 s77, s3, s73
    s_lshr_b32 s3, s82, 1
    s_xor_b32 s3, s3, 0
    s_mul_i32 s3, s3, 200704
    s_add_u32 s3, s3, s73
    s_add_u32 s3, s3, 86016
    s_mul_i32 s4, s47, 14336
    s_add_u32 s78, s3, s4
    s_sub_u32 s3, s3, s4
    s_add_u32 s79, s3, 14336
    s_lshr_b32 s3, s82, 1
    s_xor_b32 s3, s3, 1
    s_mul_i32 s3, s3, 200704
    s_add_u32 s3, s3, s73
    s_add_u32 s3, s3, 86016
    s_mul_i32 s4, s47, 14336
    s_add_u32 s80, s3, s4
    s_sub_u32 s3, s3, s4
    s_add_u32 s81, s3, 14336
    v_lshrrev_b32 v8, 2, v2
    v_mul_u32_u24 v24, 224, v8
    v_and_b32 v8, 3, v2
    v_lshl_add_u32 v24, v8, 3, v24
    v_add_u32 v25, 65536, v24
    s_mov_b32 s84, 0x3fb8aa3b
    s_mov_b32 s85, 0x3fb8aa3b
    s_xor_b32 s4, s45, 0
    s_mul_i32 s86, s46, 116736
    s_mul_i32 s3, s4, 7296
    s_add_u32 s86, s86, s3
    s_xor_b32 s4, s45, 1
    s_mul_i32 s87, s46, 116736
    s_mul_i32 s3, s4, 7296
    s_add_u32 s87, s87, s3
    s_xor_b32 s4, s45, 2
    s_mul_i32 s88, s46, 116736
    s_mul_i32 s3, s4, 7296
    s_add_u32 s88, s88, s3
    s_xor_b32 s4, s45, 3
    s_mul_i32 s89, s46, 116736
    s_mul_i32 s3, s4, 7296
    s_add_u32 s89, s89, s3
    s_mul_i32 s90, s46, 116736
    s_mul_i32 s3, s49, 29184
    s_add_u32 s90, s90, s3
    s_mul_i32 s3, s48, 7296
    s_add_u32 s90, s90, s3
    s_add_u32 s90, s90, 0x800000
    s_add_u32 s92, s86, 7168
    s_add_u32 s93, s90, 7168
    v_add_u32 v5, 4096, v9
    v_add_u32 v6, 8192, v9
    v_add_u32 v7, 155648, v9
    v_mov_b32 v132, 2.0
    v_mov_b32 v133, 2.0
    v_mov_b32 v134, -2.0
    v_mov_b32 v135, -2.0
    v_mov_b32 v136, 1.0
    v_mov_b32 v137, 1.0
    s_lshl_b32 s70, s51, 7
    s_add_u32 s70, s70, s68
    s_mul_i32 s71, s51, 229376
    s_add_u32 s71, s71, s69
    s_add_u32 m0, s53, 16384
    s_nop 0
    buffer_load_dwordx4 v20, s[16:19], s70 offen lds
    s_add_u32 m0, s53, 17408
    s_nop 0
    buffer_load_dwordx4 v21, s[16:19], s70 offen lds
    s_add_u32 m0, s72, 79872
    s_mov_b32 exec_hi, 0xffffff
    buffer_load_dwordx4 v22, s[20:23], s71 offen lds
    s_mov_b32 exec_hi, -1
    s_add_u32 s71, s71, 14336
    s_add_u32 m0, s72, 83456
    s_mov_b32 exec_hi, 0xffffff
    buffer_load_dwordx4 v22, s[20:23], s71 offen lds
    s_mov_b32 exec_hi, -1
    s_add_u32 s70, s70, 917504
    s_add_u32 m0, s53, 18432
    s_nop 0
    buffer_load_dwordx4 v20, s[16:19], s70 offen lds
    s_add_u32 m0, s53, 19456
    s_nop 0
    buffer_load_dwordx4 v21, s[16:19], s70 offen lds
    s_add_u32 s71, s71, 100352
    s_add_u32 m0, s72, 87040
    s_mov_b32 exec_hi, 0xffffff
    buffer_load_dwordx4 v22, s[20:23], s71 offen lds
    s_mov_b32 exec_hi, -1
    s_add_u32 s71, s71, 14336
    s_add_u32 m0, s72, 90624
    s_mov_b32 exec_hi, 0xffffff
    buffer_load_dwordx4 v22, s[20:23], s71 offen lds
    s_mov_b32 exec_hi, -1
    s_add_u32 s51, s51, 1
    s_cmp_eq_u32 s51, 7
    s_cselect_b32 s51, 0, s51
    s_waitcnt vmcnt(8)
    s_waitcnt vmcnt(15) lgkmcnt(0)
    s_barrier
    ds_read_b128 a[56:59], v12 offset:0
    ds_read_b128 a[60:63], v12 offset:2048
    ds_read_b64_tr_b16 a[24:25], v25 offset:192
    ds_read_b64_tr_b16 a[26:27], v25 offset:3776
    ds_read_b64_tr_b16 a[0:1], v25 offset:0
    ds_read_b64_tr_b16 a[2:3], v25 offset:3584
    ds_read_b64_tr_b16 a[4:5], v25 offset:32
    ds_read_b64_tr_b16 a[6:7], v25 offset:3616
    ds_read_b64_tr_b16 a[8:9], v25 offset:64
    ds_read_b64_tr_b16 a[10:11], v25 offset:3648
    ds_read_b64_tr_b16 a[12:13], v25 offset:96
    ds_read_b64_tr_b16 a[14:15], v25 offset:3680
    ds_read_b64_tr_b16 a[16:17], v25 offset:128
    ds_read_b64_tr_b16 a[18:19], v25 offset:3712
    ds_read_b64_tr_b16 a[20:21], v25 offset:160
    ds_read_b64_tr_b16 a[22:23], v25 offset:3744
    v_lshlrev_b32 v84, 16, v28
    v_and_b32 v85, 0xffff0000, v28
    v_lshlrev_b32 v86, 16, v29
    v_and_b32 v87, 0xffff0000, v29
    v_lshlrev_b32 v88, 16, v30
    v_and_b32 v89, 0xffff0000, v30
    v_lshlrev_b32 v90, 16, v31
    v_and_b32 v91, 0xffff0000, v31
    v_lshlrev_b32 v92, 16, v32
    v_and_b32 v93, 0xffff0000, v32
    v_lshlrev_b32 v94, 16, v33
    v_and_b32 v95, 0xffff0000, v33
    v_lshlrev_b32 v96, 16, v34
    v_and_b32 v97, 0xffff0000, v34
    v_lshlrev_b32 v98, 16, v35
    v_and_b32 v99, 0xffff0000, v35
    v_lshlrev_b32 v100, 16, v36
    v_and_b32 v101, 0xffff0000, v36
    v_lshlrev_b32 v102, 16, v37
    v_and_b32 v103, 0xffff0000, v37
    v_lshlrev_b32 v104, 16, v38
    v_and_b32 v105, 0xffff0000, v38
    v_lshlrev_b32 v106, 16, v39
    v_and_b32 v107, 0xffff0000, v39
    v_lshlrev_b32 v108, 16, v40
    v_and_b32 v109, 0xffff0000, v40
    v_lshlrev_b32 v110, 16, v41
    v_and_b32 v111, 0xffff0000, v41
    s_mul_i32 s7, s14, 0x9e3779b1
    s_add_u32 s7, s7, 0x7f4a7c15
    v_mov_b32 v11, s7
    s_waitcnt lgkmcnt(8)
    v_mfma_f32_16x16x32_bf16 v[52:55], a[24:27], a[56:59], v[108:111]
    ds_read_b128 a[64:67], v13 offset:0
    ds_read_b128 a[68:71], v13 offset:2048
    v_mfma_f32_16x16x32_bf16 v[80:83], a[24:27], a[60:63], v[108:111]
    ds_read_b64_tr_b16 a[52:53], v25 offset:7360
    ds_read_b64_tr_b16 a[54:55], v25 offset:10944
    v_mfma_f32_16x16x32_bf16 v[28:31], a[0:3], a[56:59], v[84:87]
    ds_read_b64_tr_b16 a[28:29], v25 offset:7168
    v_mfma_f32_16x16x32_bf16 v[56:59], a[0:3], a[60:63], v[84:87]
    ds_read_b64_tr_b16 a[30:31], v25 offset:10752
    v_mfma_f32_16x16x32_bf16 v[32:35], a[4:7], a[56:59], v[88:91]
    ds_read_b64_tr_b16 a[32:33], v25 offset:7200
    v_mfma_f32_16x16x32_bf16 v[60:63], a[4:7], a[60:63], v[88:91]
    ds_read_b64_tr_b16 a[34:35], v25 offset:10784
    s_waitcnt lgkmcnt(10)
    v_mfma_f32_16x16x32_bf16 v[36:39], a[8:11], a[56:59], v[92:95]
    ds_read_b64_tr_b16 a[36:37], v25 offset:7232
    v_mfma_f32_16x16x32_bf16 v[64:67], a[8:11], a[60:63], v[92:95]
    ds_read_b64_tr_b16 a[38:39], v25 offset:10816
    v_mfma_f32_16x16x32_bf16 v[40:43], a[12:15], a[56:59], v[96:99]
    ds_read_b64_tr_b16 a[40:41], v25 offset:7264
    v_mfma_f32_16x16x32_bf16 v[68:71], a[12:15], a[60:63], v[96:99]
    ds_read_b64_tr_b16 a[42:43], v25 offset:10848
    v_mfma_f32_16x16x32_bf16 v[44:47], a[16:19], a[56:59], v[100:103]
    ds_read_b64_tr_b16 a[44:45], v25 offset:7296
    v_mfma_f32_16x16x32_bf16 v[72:75], a[16:19], a[60:63], v[100:103]
    ds_read_b64_tr_b16 a[46:47], v25 offset:10880
    s_waitcnt lgkmcnt(14)
    v_mfma_f32_16x16x32_bf16 v[48:51], a[20:23], a[56:59], v[104:107]
    ds_read_b64_tr_b16 a[48:49], v25 offset:7328
    v_mfma_f32_16x16x32_bf16 v[76:79], a[20:23], a[60:63], v[104:107]
    ds_read_b64_tr_b16 a[50:51], v25 offset:10912
    s_waitcnt vmcnt(0)
    s_barrier
    s_waitcnt lgkmcnt(8)
    v_mfma_f32_16x16x32_bf16 v[52:55], a[52:55], a[64:67], v[52:55]
    ds_read_b128 a[56:59], v12 offset:16384
    ds_read_b128 a[60:63], v12 offset:18432
    v_mfma_f32_16x16x32_bf16 v[80:83], a[52:55], a[68:71], v[80:83]
    ds_read_b64_tr_b16 a[24:25], v25 offset:14528
    ds_read_b64_tr_b16 a[26:27], v25 offset:18112
    v_mfma_f32_16x16x32_bf16 v[28:31], a[28:31], a[64:67], v[28:31]
    ds_read_b64_tr_b16 a[0:1], v25 offset:14336
    v_mfma_f32_16x16x32_bf16 v[56:59], a[28:31], a[68:71], v[56:59]
    ds_read_b64_tr_b16 a[2:3], v25 offset:17920
    v_mfma_f32_16x16x32_bf16 v[32:35], a[32:35], a[64:67], v[32:35]
    ds_read_b64_tr_b16 a[4:5], v25 offset:14368
    v_mfma_f32_16x16x32_bf16 v[60:63], a[32:35], a[68:71], v[60:63]
    ds_read_b64_tr_b16 a[6:7], v25 offset:17952
    s_waitcnt lgkmcnt(10)
    v_mfma_f32_16x16x32_bf16 v[36:39], a[36:39], a[64:67], v[36:39]
    ds_read_b64_tr_b16 a[8:9], v25 offset:14400
    v_mfma_f32_16x16x32_bf16 v[64:67], a[36:39], a[68:71], v[64:67]
    ds_read_b64_tr_b16 a[10:11], v25 offset:17984
    v_mfma_f32_16x16x32_bf16 v[40:43], a[40:43], a[64:67], v[40:43]
    ds_read_b64_tr_b16 a[12:13], v25 offset:14432
    v_mfma_f32_16x16x32_bf16 v[68:71], a[40:43], a[68:71], v[68:71]
    ds_read_b64_tr_b16 a[14:15], v25 offset:18016
    v_mfma_f32_16x16x32_bf16 v[44:47], a[44:47], a[64:67], v[44:47]
    ds_read_b64_tr_b16 a[16:17], v25 offset:14464
    v_mfma_f32_16x16x32_bf16 v[72:75], a[44:47], a[68:71], v[72:75]
    ds_read_b64_tr_b16 a[18:19], v25 offset:18048
    s_waitcnt lgkmcnt(14)
    v_mfma_f32_16x16x32_bf16 v[48:51], a[48:51], a[64:67], v[48:51]
    ds_read_b64_tr_b16 a[20:21], v25 offset:14496
    v_mfma_f32_16x16x32_bf16 v[76:79], a[48:51], a[68:71], v[76:79]
    ds_read_b64_tr_b16 a[22:23], v25 offset:18080
    s_waitcnt lgkmcnt(8)
    v_mfma_f32_16x16x32_bf16 v[52:55], a[24:27], a[56:59], v[52:55]
    ds_read_b128 a[64:67], v13 offset:16384
    ds_read_b128 a[68:71], v13 offset:18432
    v_mfma_f32_16x16x32_bf16 v[80:83], a[24:27], a[60:63], v[80:83]
    ds_read_b64_tr_b16 a[52:53], v25 offset:21696
    ds_read_b64_tr_b16 a[54:55], v25 offset:25280
    v_mfma_f32_16x16x32_bf16 v[28:31], a[0:3], a[56:59], v[28:31]
    ds_read_b64_tr_b16 a[28:29], v25 offset:21504
    v_mfma_f32_16x16x32_bf16 v[56:59], a[0:3], a[60:63], v[56:59]
    ds_read_b64_tr_b16 a[30:31], v25 offset:25088
    v_mfma_f32_16x16x32_bf16 v[32:35], a[4:7], a[56:59], v[32:35]
    ds_read_b64_tr_b16 a[32:33], v25 offset:21536
    v_mfma_f32_16x16x32_bf16 v[60:63], a[4:7], a[60:63], v[60:63]
    ds_read_b64_tr_b16 a[34:35], v25 offset:25120
    s_waitcnt lgkmcnt(10)
    v_mfma_f32_16x16x32_bf16 v[36:39], a[8:11], a[56:59], v[36:39]
    ds_read_b64_tr_b16 a[36:37], v25 offset:21568
    v_mfma_f32_16x16x32_bf16 v[64:67], a[8:11], a[60:63], v[64:67]
    ds_read_b64_tr_b16 a[38:39], v25 offset:25152
    v_mfma_f32_16x16x32_bf16 v[40:43], a[12:15], a[56:59], v[40:43]
    ds_read_b64_tr_b16 a[40:41], v25 offset:21600
    v_mfma_f32_16x16x32_bf16 v[68:71], a[12:15], a[60:63], v[68:71]
    ds_read_b64_tr_b16 a[42:43], v25 offset:25184
    v_mfma_f32_16x16x32_bf16 v[44:47], a[16:19], a[56:59], v[44:47]
    ds_read_b64_tr_b16 a[44:45], v25 offset:21632
    v_mfma_f32_16x16x32_bf16 v[72:75], a[16:19], a[60:63], v[72:75]
    ds_read_b64_tr_b16 a[46:47], v25 offset:25216
    s_waitcnt lgkmcnt(14)
    v_mfma_f32_16x16x32_bf16 v[48:51], a[20:23], a[56:59], v[48:51]
    ds_read_b64_tr_b16 a[48:49], v25 offset:21664
    v_mfma_f32_16x16x32_bf16 v[76:79], a[20:23], a[60:63], v[76:79]
    ds_read_b64_tr_b16 a[50:51], v25 offset:25248
    s_barrier
    s_waitcnt lgkmcnt(8)
    v_mfma_f32_16x16x32_bf16 v[52:55], a[52:55], a[64:67], v[52:55]
    ds_read_b128 a[56:59], v12 offset:32768
    ds_read_b128 a[60:63], v12 offset:34816
    v_mfma_f32_16x16x32_bf16 v[80:83], a[52:55], a[68:71], v[80:83]
    ds_read_b64_tr_b16 a[24:25], v25 offset:28864
    ds_read_b64_tr_b16 a[26:27], v25 offset:32448
    v_mfma_f32_16x16x32_bf16 v[28:31], a[28:31], a[64:67], v[28:31]
    ds_read_b64_tr_b16 a[0:1], v25 offset:28672
    v_mfma_f32_16x16x32_bf16 v[56:59], a[28:31], a[68:71], v[56:59]
    ds_read_b64_tr_b16 a[2:3], v25 offset:32256
    v_mfma_f32_16x16x32_bf16 v[32:35], a[32:35], a[64:67], v[32:35]
    ds_read_b64_tr_b16 a[4:5], v25 offset:28704
    v_mfma_f32_16x16x32_bf16 v[60:63], a[32:35], a[68:71], v[60:63]
    ds_read_b64_tr_b16 a[6:7], v25 offset:32288
    s_waitcnt lgkmcnt(10)
    v_mfma_f32_16x16x32_bf16 v[36:39], a[36:39], a[64:67], v[36:39]
    ds_read_b64_tr_b16 a[8:9], v25 offset:28736
    v_mfma_f32_16x16x32_bf16 v[64:67], a[36:39], a[68:71], v[64:67]
    ds_read_b64_tr_b16 a[10:11], v25 offset:32320
    v_mfma_f32_16x16x32_bf16 v[40:43], a[40:43], a[64:67], v[40:43]
    ds_read_b64_tr_b16 a[12:13], v25 offset:28768
    v_mfma_f32_16x16x32_bf16 v[68:71], a[40:43], a[68:71], v[68:71]
    ds_read_b64_tr_b16 a[14:15], v25 offset:32352
    v_mfma_f32_16x16x32_bf16 v[44:47], a[44:47], a[64:67], v[44:47]
    ds_read_b64_tr_b16 a[16:17], v25 offset:28800
    v_mfma_f32_16x16x32_bf16 v[72:75], a[44:47], a[68:71], v[72:75]
    ds_read_b64_tr_b16 a[18:19], v25 offset:32384
    s_waitcnt lgkmcnt(14)
    v_mfma_f32_16x16x32_bf16 v[48:51], a[48:51], a[64:67], v[48:51]
    ds_read_b64_tr_b16 a[20:21], v25 offset:28832
    v_mfma_f32_16x16x32_bf16 v[76:79], a[48:51], a[68:71], v[76:79]
    ds_read_b64_tr_b16 a[22:23], v25 offset:32416
    s_waitcnt lgkmcnt(8)
    v_mfma_f32_16x16x32_bf16 v[52:55], a[24:27], a[56:59], v[52:55]
    ds_read_b128 a[64:67], v13 offset:32768
    ds_read_b128 a[68:71], v13 offset:34816
    v_mfma_f32_16x16x32_bf16 v[80:83], a[24:27], a[60:63], v[80:83]
    ds_read_b64_tr_b16 a[52:53], v25 offset:36032
    ds_read_b64_tr_b16 a[54:55], v25 offset:39616
    v_mfma_f32_16x16x32_bf16 v[28:31], a[0:3], a[56:59], v[28:31]
    ds_read_b64_tr_b16 a[28:29], v25 offset:35840
    v_mfma_f32_16x16x32_bf16 v[56:59], a[0:3], a[60:63], v[56:59]
    ds_read_b64_tr_b16 a[30:31], v25 offset:39424
    v_mfma_f32_16x16x32_bf16 v[32:35], a[4:7], a[56:59], v[32:35]
    ds_read_b64_tr_b16 a[32:33], v25 offset:35872
    v_mfma_f32_16x16x32_bf16 v[60:63], a[4:7], a[60:63], v[60:63]
    ds_read_b64_tr_b16 a[34:35], v25 offset:39456
    s_waitcnt lgkmcnt(10)
    v_mfma_f32_16x16x32_bf16 v[36:39], a[8:11], a[56:59], v[36:39]
    ds_read_b64_tr_b16 a[36:37], v25 offset:35904
    v_mfma_f32_16x16x32_bf16 v[64:67], a[8:11], a[60:63], v[64:67]
    ds_read_b64_tr_b16 a[38:39], v25 offset:39488
    v_mfma_f32_16x16x32_bf16 v[40:43], a[12:15], a[56:59], v[40:43]
    ds_read_b64_tr_b16 a[40:41], v25 offset:35936
    v_mfma_f32_16x16x32_bf16 v[68:71], a[12:15], a[60:63], v[68:71]
    ds_read_b64_tr_b16 a[42:43], v25 offset:39520
    v_mfma_f32_16x16x32_bf16 v[44:47], a[16:19], a[56:59], v[44:47]
    ds_read_b64_tr_b16 a[44:45], v25 offset:35968
    v_mfma_f32_16x16x32_bf16 v[72:75], a[16:19], a[60:63], v[72:75]
    ds_read_b64_tr_b16 a[46:47], v25 offset:39552
    s_waitcnt lgkmcnt(14)
    v_mfma_f32_16x16x32_bf16 v[48:51], a[20:23], a[56:59], v[48:51]
    ds_read_b64_tr_b16 a[48:49], v25 offset:36000
    v_mfma_f32_16x16x32_bf16 v[76:79], a[20:23], a[60:63], v[76:79]
    ds_read_b64_tr_b16 a[50:51], v25 offset:39584
    s_barrier
    s_waitcnt lgkmcnt(8)
    v_mfma_f32_16x16x32_bf16 v[52:55], a[52:55], a[64:67], v[52:55]
    ds_read_b128 a[56:59], v12 offset:49152
    ds_read_b128 a[60:63], v12 offset:51200
    v_mfma_f32_16x16x32_bf16 v[80:83], a[52:55], a[68:71], v[80:83]
    ds_read_b64_tr_b16 a[24:25], v25 offset:43200
    ds_read_b64_tr_b16 a[26:27], v25 offset:46784
    v_mfma_f32_16x16x32_bf16 v[28:31], a[28:31], a[64:67], v[28:31]
    ds_read_b64_tr_b16 a[0:1], v25 offset:43008
    v_mfma_f32_16x16x32_bf16 v[56:59], a[28:31], a[68:71], v[56:59]
    ds_read_b64_tr_b16 a[2:3], v25 offset:46592
    v_mfma_f32_16x16x32_bf16 v[32:35], a[32:35], a[64:67], v[32:35]
    ds_read_b64_tr_b16 a[4:5], v25 offset:43040
    v_mfma_f32_16x16x32_bf16 v[60:63], a[32:35], a[68:71], v[60:63]
    ds_read_b64_tr_b16 a[6:7], v25 offset:46624
    s_waitcnt lgkmcnt(10)
    v_mfma_f32_16x16x32_bf16 v[36:39], a[36:39], a[64:67], v[36:39]
    ds_read_b64_tr_b16 a[8:9], v25 offset:43072
    v_mfma_f32_16x16x32_bf16 v[64:67], a[36:39], a[68:71], v[64:67]
    ds_read_b64_tr_b16 a[10:11], v25 offset:46656
    v_mfma_f32_16x16x32_bf16 v[40:43], a[40:43], a[64:67], v[40:43]
    ds_read_b64_tr_b16 a[12:13], v25 offset:43104
    v_mfma_f32_16x16x32_bf16 v[68:71], a[40:43], a[68:71], v[68:71]
    ds_read_b64_tr_b16 a[14:15], v25 offset:46688
    v_mfma_f32_16x16x32_bf16 v[44:47], a[44:47], a[64:67], v[44:47]
    ds_read_b64_tr_b16 a[16:17], v25 offset:43136
    v_mfma_f32_16x16x32_bf16 v[72:75], a[44:47], a[68:71], v[72:75]
    ds_read_b64_tr_b16 a[18:19], v25 offset:46720
    s_waitcnt lgkmcnt(14)
    v_mfma_f32_16x16x32_bf16 v[48:51], a[48:51], a[64:67], v[48:51]
    ds_read_b64_tr_b16 a[20:21], v25 offset:43168
    v_mfma_f32_16x16x32_bf16 v[76:79], a[48:51], a[68:71], v[76:79]
    ds_read_b64_tr_b16 a[22:23], v25 offset:46752
    s_waitcnt lgkmcnt(8)
    v_mfma_f32_16x16x32_bf16 v[52:55], a[24:27], a[56:59], v[52:55]
    ds_read_b128 a[64:67], v13 offset:49152
    ds_read_b128 a[68:71], v13 offset:51200
    v_mfma_f32_16x16x32_bf16 v[80:83], a[24:27], a[60:63], v[80:83]
    ds_read_b64_tr_b16 a[52:53], v25 offset:50368
    ds_read_b64_tr_b16 a[54:55], v25 offset:53952
    v_mfma_f32_16x16x32_bf16 v[28:31], a[0:3], a[56:59], v[28:31]
    ds_read_b64_tr_b16 a[28:29], v25 offset:50176
    v_mfma_f32_16x16x32_bf16 v[56:59], a[0:3], a[60:63], v[56:59]
    ds_read_b64_tr_b16 a[30:31], v25 offset:53760
    v_mfma_f32_16x16x32_bf16 v[32:35], a[4:7], a[56:59], v[32:35]
    ds_read_b64_tr_b16 a[32:33], v25 offset:50208
    v_mfma_f32_16x16x32_bf16 v[60:63], a[4:7], a[60:63], v[60:63]
    ds_read_b64_tr_b16 a[34:35], v25 offset:53792
    s_waitcnt lgkmcnt(10)
    v_mfma_f32_16x16x32_bf16 v[36:39], a[8:11], a[56:59], v[36:39]
    ds_read_b64_tr_b16 a[36:37], v25 offset:50240
    v_mfma_f32_16x16x32_bf16 v[64:67], a[8:11], a[60:63], v[64:67]
    ds_read_b64_tr_b16 a[38:39], v25 offset:53824
    v_mfma_f32_16x16x32_bf16 v[40:43], a[12:15], a[56:59], v[40:43]
    ds_read_b64_tr_b16 a[40:41], v25 offset:50272
    v_mfma_f32_16x16x32_bf16 v[68:71], a[12:15], a[60:63], v[68:71]
    ds_read_b64_tr_b16 a[42:43], v25 offset:53856
    v_mfma_f32_16x16x32_bf16 v[44:47], a[16:19], a[56:59], v[44:47]
    ds_read_b64_tr_b16 a[44:45], v25 offset:50304
    v_mfma_f32_16x16x32_bf16 v[72:75], a[16:19], a[60:63], v[72:75]
    ds_read_b64_tr_b16 a[46:47], v25 offset:53888
    s_waitcnt lgkmcnt(14)
    v_mfma_f32_16x16x32_bf16 v[48:51], a[20:23], a[56:59], v[48:51]
    ds_read_b64_tr_b16 a[48:49], v25 offset:50336
    v_mfma_f32_16x16x32_bf16 v[76:79], a[20:23], a[60:63], v[76:79]
    ds_read_b64_tr_b16 a[50:51], v25 offset:53920
    s_barrier
    s_waitcnt lgkmcnt(8)
    v_mfma_f32_16x16x32_bf16 v[52:55], a[52:55], a[64:67], v[52:55]
    ds_read_b128 a[56:59], v12 offset:0
    ds_read_b128 a[60:63], v12 offset:2048
    v_mfma_f32_16x16x32_bf16 v[80:83], a[52:55], a[68:71], v[80:83]
    ds_read_b64_tr_b16 a[24:25], v25 offset:192
    ds_read_b64_tr_b16 a[26:27], v25 offset:3776
    v_mfma_f32_16x16x32_bf16 v[28:31], a[28:31], a[64:67], v[28:31]
    ds_read_b64_tr_b16 a[0:1], v25 offset:0
    v_mfma_f32_16x16x32_bf16 v[56:59], a[28:31], a[68:71], v[56:59]
    ds_read_b64_tr_b16 a[2:3], v25 offset:3584
    v_mfma_f32_16x16x32_bf16 v[32:35], a[32:35], a[64:67], v[32:35]
    ds_read_b64_tr_b16 a[4:5], v25 offset:32
    v_mfma_f32_16x16x32_bf16 v[60:63], a[32:35], a[68:71], v[60:63]
    ds_read_b64_tr_b16 a[6:7], v25 offset:3616
    s_waitcnt lgkmcnt(10)
    v_mfma_f32_16x16x32_bf16 v[36:39], a[36:39], a[64:67], v[36:39]
    ds_read_b64_tr_b16 a[8:9], v25 offset:64
    v_mfma_f32_16x16x32_bf16 v[64:67], a[36:39], a[68:71], v[64:67]
    ds_read_b64_tr_b16 a[10:11], v25 offset:3648
    v_mfma_f32_16x16x32_bf16 v[40:43], a[40:43], a[64:67], v[40:43]
    ds_read_b64_tr_b16 a[12:13], v25 offset:96
    v_mfma_f32_16x16x32_bf16 v[68:71], a[40:43], a[68:71], v[68:71]
    ds_read_b64_tr_b16 a[14:15], v25 offset:3680
    v_mfma_f32_16x16x32_bf16 v[44:47], a[44:47], a[64:67], v[44:47]
    ds_read_b64_tr_b16 a[16:17], v25 offset:128
    v_mfma_f32_16x16x32_bf16 v[72:75], a[44:47], a[68:71], v[72:75]
    ds_read_b64_tr_b16 a[18:19], v25 offset:3712
    s_waitcnt lgkmcnt(14)
    v_mfma_f32_16x16x32_bf16 v[48:51], a[48:51], a[64:67], v[48:51]
    ds_read_b64_tr_b16 a[20:21], v25 offset:160
    v_mfma_f32_16x16x32_bf16 v[76:79], a[48:51], a[68:71], v[76:79]
    ds_read_b64_tr_b16 a[22:23], v25 offset:3744
    s_waitcnt lgkmcnt(8)
    v_mfma_f32_16x16x32_bf16 v[52:55], a[24:27], a[56:59], v[52:55]
    ds_read_b128 a[64:67], v13 offset:0
    ds_read_b128 a[68:71], v13 offset:2048
    v_mfma_f32_16x16x32_bf16 v[80:83], a[24:27], a[60:63], v[80:83]
    ds_read_b64_tr_b16 a[52:53], v25 offset:7360
    ds_read_b64_tr_b16 a[54:55], v25 offset:10944
    v_mfma_f32_16x16x32_bf16 v[28:31], a[0:3], a[56:59], v[28:31]
    ds_read_b64_tr_b16 a[28:29], v25 offset:7168
    v_mfma_f32_16x16x32_bf16 v[56:59], a[0:3], a[60:63], v[56:59]
    ds_read_b64_tr_b16 a[30:31], v25 offset:10752
    v_mfma_f32_16x16x32_bf16 v[32:35], a[4:7], a[56:59], v[32:35]
    ds_read_b64_tr_b16 a[32:33], v25 offset:7200
    v_mfma_f32_16x16x32_bf16 v[60:63], a[4:7], a[60:63], v[60:63]
    ds_read_b64_tr_b16 a[34:35], v25 offset:10784
    s_waitcnt lgkmcnt(10)
    v_mfma_f32_16x16x32_bf16 v[36:39], a[8:11], a[56:59], v[36:39]
    ds_read_b64_tr_b16 a[36:37], v25 offset:7232
    v_mfma_f32_16x16x32_bf16 v[64:67], a[8:11], a[60:63], v[64:67]
    ds_read_b64_tr_b16 a[38:39], v25 offset:10816
    v_mfma_f32_16x16x32_bf16 v[40:43], a[12:15], a[56:59], v[40:43]
    ds_read_b64_tr_b16 a[40:41], v25 offset:7264
    v_mfma_f32_16x16x32_bf16 v[68:71], a[12:15], a[60:63], v[68:71]
    ds_read_b64_tr_b16 a[42:43], v25 offset:10848
    v_mfma_f32_16x16x32_bf16 v[44:47], a[16:19], a[56:59], v[44:47]
    ds_read_b64_tr_b16 a[44:45], v25 offset:7296
    v_mfma_f32_16x16x32_bf16 v[72:75], a[16:19], a[60:63], v[72:75]
    ds_read_b64_tr_b16 a[46:47], v25 offset:10880
    s_waitcnt lgkmcnt(14)
    v_mfma_f32_16x16x32_bf16 v[48:51], a[20:23], a[56:59], v[48:51]
    ds_read_b64_tr_b16 a[48:49], v25 offset:7328
    v_mfma_f32_16x16x32_bf16 v[76:79], a[20:23], a[60:63], v[76:79]
    ds_read_b64_tr_b16 a[50:51], v25 offset:10912
    s_barrier
    s_waitcnt lgkmcnt(8)
    v_mfma_f32_16x16x32_bf16 v[52:55], a[52:55], a[64:67], v[52:55]
    ds_read_b128 a[56:59], v12 offset:16384
    ds_read_b128 a[60:63], v12 offset:18432
    v_mfma_f32_16x16x32_bf16 v[80:83], a[52:55], a[68:71], v[80:83]
    ds_read_b64_tr_b16 a[24:25], v25 offset:14528
    ds_read_b64_tr_b16 a[26:27], v25 offset:18112
    v_mfma_f32_16x16x32_bf16 v[28:31], a[28:31], a[64:67], v[28:31]
    ds_read_b64_tr_b16 a[0:1], v25 offset:14336
    v_mfma_f32_16x16x32_bf16 v[56:59], a[28:31], a[68:71], v[56:59]
    ds_read_b64_tr_b16 a[2:3], v25 offset:17920
    v_mfma_f32_16x16x32_bf16 v[32:35], a[32:35], a[64:67], v[32:35]
    ds_read_b64_tr_b16 a[4:5], v25 offset:14368
    v_mfma_f32_16x16x32_bf16 v[60:63], a[32:35], a[68:71], v[60:63]
    ds_read_b64_tr_b16 a[6:7], v25 offset:17952
    s_waitcnt lgkmcnt(10)
    v_mfma_f32_16x16x32_bf16 v[36:39], a[36:39], a[64:67], v[36:39]
    ds_read_b64_tr_b16 a[8:9], v25 offset:14400
    v_mfma_f32_16x16x32_bf16 v[64:67], a[36:39], a[68:71], v[64:67]
    ds_read_b64_tr_b16 a[10:11], v25 offset:17984
    v_mfma_f32_16x16x32_bf16 v[40:43], a[40:43], a[64:67], v[40:43]
    ds_read_b64_tr_b16 a[12:13], v25 offset:14432
    v_mfma_f32_16x16x32_bf16 v[68:71], a[40:43], a[68:71], v[68:71]
    ds_read_b64_tr_b16 a[14:15], v25 offset:18016
    v_mfma_f32_16x16x32_bf16 v[44:47], a[44:47], a[64:67], v[44:47]
    ds_read_b64_tr_b16 a[16:17], v25 offset:14464
    v_mfma_f32_16x16x32_bf16 v[72:75], a[44:47], a[68:71], v[72:75]
    ds_read_b64_tr_b16 a[18:19], v25 offset:18048
    s_waitcnt lgkmcnt(14)
    v_mfma_f32_16x16x32_bf16 v[48:51], a[48:51], a[64:67], v[48:51]
    ds_read_b64_tr_b16 a[20:21], v25 offset:14496
    v_mfma_f32_16x16x32_bf16 v[76:79], a[48:51], a[68:71], v[76:79]
    ds_read_b64_tr_b16 a[22:23], v25 offset:18080
    s_waitcnt lgkmcnt(8)
    v_mfma_f32_16x16x32_bf16 v[52:55], a[24:27], a[56:59], v[52:55]
    ds_read_b128 a[64:67], v13 offset:16384
    ds_read_b128 a[68:71], v13 offset:18432
    v_mfma_f32_16x16x32_bf16 v[80:83], a[24:27], a[60:63], v[80:83]
    ds_read_b64_tr_b16 a[52:53], v25 offset:21696
    ds_read_b64_tr_b16 a[54:55], v25 offset:25280
    v_mfma_f32_16x16x32_bf16 v[28:31], a[0:3], a[56:59], v[28:31]
    ds_read_b64_tr_b16 a[28:29], v25 offset:21504
    v_mfma_f32_16x16x32_bf16 v[56:59], a[0:3], a[60:63], v[56:59]
    ds_read_b64_tr_b16 a[30:31], v25 offset:25088
    v_mfma_f32_16x16x32_bf16 v[32:35], a[4:7], a[56:59], v[32:35]
    ds_read_b64_tr_b16 a[32:33], v25 offset:21536
    v_mfma_f32_16x16x32_bf16 v[60:63], a[4:7], a[60:63], v[60:63]
    ds_read_b64_tr_b16 a[34:35], v25 offset:25120
    s_waitcnt lgkmcnt(10)
    v_mfma_f32_16x16x32_bf16 v[36:39], a[8:11], a[56:59], v[36:39]
    ds_read_b64_tr_b16 a[36:37], v25 offset:21568
    v_mfma_f32_16x16x32_bf16 v[64:67], a[8:11], a[60:63], v[64:67]
    ds_read_b64_tr_b16 a[38:39], v25 offset:25152
    v_mfma_f32_16x16x32_bf16 v[40:43], a[12:15], a[56:59], v[40:43]
    ds_read_b64_tr_b16 a[40:41], v25 offset:21600
    v_mfma_f32_16x16x32_bf16 v[68:71], a[12:15], a[60:63], v[68:71]
    ds_read_b64_tr_b16 a[42:43], v25 offset:25184
    v_mfma_f32_16x16x32_bf16 v[44:47], a[16:19], a[56:59], v[44:47]
    ds_read_b64_tr_b16 a[44:45], v25 offset:21632
    v_mfma_f32_16x16x32_bf16 v[72:75], a[16:19], a[60:63], v[72:75]
    ds_read_b64_tr_b16 a[46:47], v25 offset:25216
    s_waitcnt lgkmcnt(14)
    v_mfma_f32_16x16x32_bf16 v[48:51], a[20:23], a[56:59], v[48:51]
    ds_read_b64_tr_b16 a[48:49], v25 offset:21664
    v_mfma_f32_16x16x32_bf16 v[76:79], a[20:23], a[60:63], v[76:79]
    ds_read_b64_tr_b16 a[50:51], v25 offset:25248
    s_barrier
    s_waitcnt lgkmcnt(8)
    v_mfma_f32_16x16x32_bf16 v[52:55], a[52:55], a[64:67], v[52:55]
    ds_read_b128 a[56:59], v12 offset:32768
    ds_read_b128 a[60:63], v12 offset:34816
    v_mfma_f32_16x16x32_bf16 v[80:83], a[52:55], a[68:71], v[80:83]
    ds_read_b64_tr_b16 a[24:25], v25 offset:28864
    ds_read_b64_tr_b16 a[26:27], v25 offset:32448
    v_mfma_f32_16x16x32_bf16 v[28:31], a[28:31], a[64:67], v[28:31]
    ds_read_b64_tr_b16 a[0:1], v25 offset:28672
    v_mfma_f32_16x16x32_bf16 v[56:59], a[28:31], a[68:71], v[56:59]
    ds_read_b64_tr_b16 a[2:3], v25 offset:32256
    v_mfma_f32_16x16x32_bf16 v[32:35], a[32:35], a[64:67], v[32:35]
    ds_read_b64_tr_b16 a[4:5], v25 offset:28704
    v_mfma_f32_16x16x32_bf16 v[60:63], a[32:35], a[68:71], v[60:63]
    ds_read_b64_tr_b16 a[6:7], v25 offset:32288
    s_waitcnt lgkmcnt(10)
    v_mfma_f32_16x16x32_bf16 v[36:39], a[36:39], a[64:67], v[36:39]
    ds_read_b64_tr_b16 a[8:9], v25 offset:28736
    v_mfma_f32_16x16x32_bf16 v[64:67], a[36:39], a[68:71], v[64:67]
    ds_read_b64_tr_b16 a[10:11], v25 offset:32320
    v_mfma_f32_16x16x32_bf16 v[40:43], a[40:43], a[64:67], v[40:43]
    ds_read_b64_tr_b16 a[12:13], v25 offset:28768
    v_mfma_f32_16x16x32_bf16 v[68:71], a[40:43], a[68:71], v[68:71]
    ds_read_b64_tr_b16 a[14:15], v25 offset:32352
    v_mfma_f32_16x16x32_bf16 v[44:47], a[44:47], a[64:67], v[44:47]
    ds_read_b64_tr_b16 a[16:17], v25 offset:28800
    v_mfma_f32_16x16x32_bf16 v[72:75], a[44:47], a[68:71], v[72:75]
    ds_read_b64_tr_b16 a[18:19], v25 offset:32384
    s_waitcnt lgkmcnt(14)
    v_mfma_f32_16x16x32_bf16 v[48:51], a[48:51], a[64:67], v[48:51]
    ds_read_b64_tr_b16 a[20:21], v25 offset:28832
    v_mfma_f32_16x16x32_bf16 v[76:79], a[48:51], a[68:71], v[76:79]
    ds_read_b64_tr_b16 a[22:23], v25 offset:32416
    s_waitcnt lgkmcnt(8)
    v_mfma_f32_16x16x32_bf16 v[52:55], a[24:27], a[56:59], v[52:55]
    ds_read_b128 a[64:67], v13 offset:32768
    ds_read_b128 a[68:71], v13 offset:34816
    v_mfma_f32_16x16x32_bf16 v[80:83], a[24:27], a[60:63], v[80:83]
    ds_read_b64_tr_b16 a[52:53], v25 offset:36032
    ds_read_b64_tr_b16 a[54:55], v25 offset:39616
    v_mfma_f32_16x16x32_bf16 v[28:31], a[0:3], a[56:59], v[28:31]
    ds_read_b64_tr_b16 a[28:29], v25 offset:35840
    v_mfma_f32_16x16x32_bf16 v[56:59], a[0:3], a[60:63], v[56:59]
    ds_read_b64_tr_b16 a[30:31], v25 offset:39424
    v_mfma_f32_16x16x32_bf16 v[32:35], a[4:7], a[56:59], v[32:35]
    ds_read_b64_tr_b16 a[32:33], v25 offset:35872
    v_mfma_f32_16x16x32_bf16 v[60:63], a[4:7], a[60:63], v[60:63]
    ds_read_b64_tr_b16 a[34:35], v25 offset:39456
    s_waitcnt lgkmcnt(10)
    v_mfma_f32_16x16x32_bf16 v[36:39], a[8:11], a[56:59], v[36:39]
    ds_read_b64_tr_b16 a[36:37], v25 offset:35904
    v_mfma_f32_16x16x32_bf16 v[64:67], a[8:11], a[60:63], v[64:67]
    ds_read_b64_tr_b16 a[38:39], v25 offset:39488
    v_mfma_f32_16x16x32_bf16 v[40:43], a[12:15], a[56:59], v[40:43]
    ds_read_b64_tr_b16 a[40:41], v25 offset:35936
    v_mfma_f32_16x16x32_bf16 v[68:71], a[12:15], a[60:63], v[68:71]
    ds_read_b64_tr_b16 a[42:43], v25 offset:39520
    v_mfma_f32_16x16x32_bf16 v[44:47], a[16:19], a[56:59], v[44:47]
    ds_read_b64_tr_b16 a[44:45], v25 offset:35968
    v_mfma_f32_16x16x32_bf16 v[72:75], a[16:19], a[60:63], v[72:75]
    ds_read_b64_tr_b16 a[46:47], v25 offset:39552
    s_waitcnt lgkmcnt(14)
    v_mfma_f32_16x16x32_bf16 v[48:51], a[20:23], a[56:59], v[48:51]
    ds_read_b64_tr_b16 a[48:49], v25 offset:36000
    v_mfma_f32_16x16x32_bf16 v[76:79], a[20:23], a[60:63], v[76:79]
    ds_read_b64_tr_b16 a[50:51], v25 offset:39584
    ds_write_b32 v19, v17 offset:144
    s_waitcnt lgkmcnt(9)
    v_mfma_f32_16x16x32_bf16 v[52:55], a[52:55], a[64:67], v[52:55]
    v_mfma_f32_16x16x32_bf16 v[80:83], a[52:55], a[68:71], v[80:83]
    v_mfma_f32_16x16x32_bf16 v[28:31], a[28:31], a[64:67], v[28:31]
    v_mfma_f32_16x16x32_bf16 v[56:59], a[28:31], a[68:71], v[56:59]
    v_mfma_f32_16x16x32_bf16 v[32:35], a[32:35], a[64:67], v[32:35]
    v_mfma_f32_16x16x32_bf16 v[60:63], a[32:35], a[68:71], v[60:63]
    s_waitcnt lgkmcnt(3)
    v_mfma_f32_16x16x32_bf16 v[36:39], a[36:39], a[64:67], v[36:39]
    v_mfma_f32_16x16x32_bf16 v[64:67], a[36:39], a[68:71], v[64:67]
    v_mfma_f32_16x16x32_bf16 v[40:43], a[40:43], a[64:67], v[40:43]
    v_mfma_f32_16x16x32_bf16 v[68:71], a[40:43], a[68:71], v[68:71]
    v_mfma_f32_16x16x32_bf16 v[44:47], a[44:47], a[64:67], v[44:47]
    v_mfma_f32_16x16x32_bf16 v[72:75], a[44:47], a[68:71], v[72:75]
    s_waitcnt lgkmcnt(1)
    v_mfma_f32_16x16x32_bf16 v[48:51], a[48:51], a[64:67], v[48:51]
    v_mfma_f32_16x16x32_bf16 v[76:79], a[48:51], a[68:71], v[76:79]
    s_setprio 0
    v_pk_mul_f32 v[116:117], v[52:53], s[84:85]
    v_pk_mul_f32 v[118:119], v[54:55], s[84:85]
    v_pk_mul_f32 v[120:121], v[80:81], s[84:85]
    v_pk_mul_f32 v[122:123], v[82:83], s[84:85]
    v_exp_f32 v116, v116
    v_exp_f32 v117, v117
    v_exp_f32 v118, v118
    v_exp_f32 v119, v119
    v_exp_f32 v120, v120
    v_exp_f32 v121, v121
    v_exp_f32 v122, v122
    v_exp_f32 v123, v123
    v_pk_add_f32 v[124:125], v[116:117], v[132:133]
    v_pk_add_f32 v[126:127], v[118:119], v[132:133]
    v_pk_add_f32 v[128:129], v[120:121], v[132:133]
    v_pk_add_f32 v[130:131], v[122:123], v[132:133]
    v_pk_fma_f32 v[116:117], v[116:117], v[124:125], v[132:133]
    v_pk_fma_f32 v[118:119], v[118:119], v[126:127], v[132:133]
    v_pk_fma_f32 v[120:121], v[120:121], v[128:129], v[132:133]
    v_pk_fma_f32 v[122:123], v[122:123], v[130:131], v[132:133]
    v_rcp_f32 v116, v116
    v_rcp_f32 v117, v117
    v_rcp_f32 v118, v118
    v_rcp_f32 v119, v119
    v_rcp_f32 v120, v120
    v_rcp_f32 v121, v121
    v_rcp_f32 v122, v122
    v_rcp_f32 v123, v123
    v_pk_fma_f32 v[116:117], v[116:117], v[134:135], v[136:137]
    v_pk_fma_f32 v[118:119], v[118:119], v[134:135], v[136:137]
    v_pk_fma_f32 v[120:121], v[120:121], v[134:135], v[136:137]
    v_pk_fma_f32 v[122:123], v[122:123], v[134:135], v[136:137]
    v_pk_mul_f32 v[116:117], v[116:117], v[52:53]
    v_pk_mul_f32 v[118:119], v[118:119], v[54:55]
    v_pk_mul_f32 v[120:121], v[120:121], v[80:81]
    v_pk_mul_f32 v[122:123], v[122:123], v[82:83]
    v_cvt_pk_bf16_f32 v164, v116, v117
    v_cvt_pk_bf16_f32 v165, v118, v119
    v_cvt_pk_bf16_f32 v166, v120, v121
    v_cvt_pk_bf16_f32 v167, v122, v123
    buffer_store_dwordx4 v[164:167], v9, s[28:31], s86 offen offset:0 sc1
    v_pk_mul_f32 v[116:117], v[28:29], s[84:85]
    v_pk_mul_f32 v[118:119], v[30:31], s[84:85]
    v_pk_mul_f32 v[120:121], v[32:33], s[84:85]
    v_pk_mul_f32 v[122:123], v[34:35], s[84:85]
    v_exp_f32 v116, v116
    v_exp_f32 v117, v117
    v_exp_f32 v118, v118
    v_exp_f32 v119, v119
    v_exp_f32 v120, v120
    v_exp_f32 v121, v121
    v_exp_f32 v122, v122
    v_exp_f32 v123, v123
    v_pk_add_f32 v[124:125], v[116:117], v[132:133]
    v_pk_add_f32 v[126:127], v[118:119], v[132:133]
    v_pk_add_f32 v[128:129], v[120:121], v[132:133]
    v_pk_add_f32 v[130:131], v[122:123], v[132:133]
    v_pk_fma_f32 v[116:117], v[116:117], v[124:125], v[132:133]
    v_pk_fma_f32 v[118:119], v[118:119], v[126:127], v[132:133]
    v_pk_fma_f32 v[120:121], v[120:121], v[128:129], v[132:133]
    v_pk_fma_f32 v[122:123], v[122:123], v[130:131], v[132:133]
    v_rcp_f32 v116, v116
    v_rcp_f32 v117, v117
    v_rcp_f32 v118, v118
    v_rcp_f32 v119, v119
    v_rcp_f32 v120, v120
    v_rcp_f32 v121, v121
    v_rcp_f32 v122, v122
    v_rcp_f32 v123, v123
    v_pk_fma_f32 v[116:117], v[116:117], v[134:135], v[136:137]
    v_pk_fma_f32 v[118:119], v[118:119], v[134:135], v[136:137]
    v_pk_fma_f32 v[120:121], v[120:121], v[134:135], v[136:137]
    v_pk_fma_f32 v[122:123], v[122:123], v[134:135], v[136:137]
    v_pk_mul_f32 v[116:117], v[116:117], v[28:29]
    v_pk_mul_f32 v[118:119], v[118:119], v[30:31]
    v_pk_mul_f32 v[120:121], v[120:121], v[32:33]
    v_pk_mul_f32 v[122:123], v[122:123], v[34:35]
    v_cvt_pk_bf16_f32 v140, v116, v117
    v_cvt_pk_bf16_f32 v141, v118, v119
    v_cvt_pk_bf16_f32 v142, v120, v121
    v_cvt_pk_bf16_f32 v143, v122, v123
    buffer_store_dwordx4 v[140:143], v9, s[28:31], s86 offen offset:1024 sc1
    v_pk_mul_f32 v[116:117], v[56:57], s[84:85]
    v_pk_mul_f32 v[118:119], v[58:59], s[84:85]
    v_pk_mul_f32 v[120:121], v[60:61], s[84:85]
    v_pk_mul_f32 v[122:123], v[62:63], s[84:85]
    v_exp_f32 v116, v116
    v_exp_f32 v117, v117
    v_exp_f32 v118, v118
    v_exp_f32 v119, v119
    v_exp_f32 v120, v120
    v_exp_f32 v121, v121
    v_exp_f32 v122, v122
    v_exp_f32 v123, v123
    v_pk_add_f32 v[124:125], v[116:117], v[132:133]
    v_pk_add_f32 v[126:127], v[118:119], v[132:133]
    v_pk_add_f32 v[128:129], v[120:121], v[132:133]
    v_pk_add_f32 v[130:131], v[122:123], v[132:133]
    v_pk_fma_f32 v[116:117], v[116:117], v[124:125], v[132:133]
    v_pk_fma_f32 v[118:119], v[118:119], v[126:127], v[132:133]
    v_pk_fma_f32 v[120:121], v[120:121], v[128:129], v[132:133]
    v_pk_fma_f32 v[122:123], v[122:123], v[130:131], v[132:133]
    v_rcp_f32 v116, v116
    v_rcp_f32 v117, v117
    v_rcp_f32 v118, v118
    v_rcp_f32 v119, v119
    v_rcp_f32 v120, v120
    v_rcp_f32 v121, v121
    v_rcp_f32 v122, v122
    v_rcp_f32 v123, v123
    v_pk_fma_f32 v[116:117], v[116:117], v[134:135], v[136:137]
    v_pk_fma_f32 v[118:119], v[118:119], v[134:135], v[136:137]
    v_pk_fma_f32 v[120:121], v[120:121], v[134:135], v[136:137]
    v_pk_fma_f32 v[122:123], v[122:123], v[134:135], v[136:137]
    v_pk_mul_f32 v[116:117], v[116:117], v[56:57]
    v_pk_mul_f32 v[118:119], v[118:119], v[58:59]
    v_pk_mul_f32 v[120:121], v[120:121], v[60:61]
    v_pk_mul_f32 v[122:123], v[122:123], v[62:63]
    v_cvt_pk_bf16_f32 v144, v116, v117
    v_cvt_pk_bf16_f32 v145, v118, v119
    v_cvt_pk_bf16_f32 v146, v120, v121
    v_cvt_pk_bf16_f32 v147, v122, v123
    buffer_store_dwordx4 v[144:147], v9, s[28:31], s86 offen offset:2048 sc1
    v_pk_mul_f32 v[116:117], v[36:37], s[84:85]
    v_pk_mul_f32 v[118:119], v[38:39], s[84:85]
    v_pk_mul_f32 v[120:121], v[40:41], s[84:85]
    v_pk_mul_f32 v[122:123], v[42:43], s[84:85]
    v_exp_f32 v116, v116
    v_exp_f32 v117, v117
    v_exp_f32 v118, v118
    v_exp_f32 v119, v119
    v_exp_f32 v120, v120
    v_exp_f32 v121, v121
    v_exp_f32 v122, v122
    v_exp_f32 v123, v123
    v_pk_add_f32 v[124:125], v[116:117], v[132:133]
    v_pk_add_f32 v[126:127], v[118:119], v[132:133]
    v_pk_add_f32 v[128:129], v[120:121], v[132:133]
    v_pk_add_f32 v[130:131], v[122:123], v[132:133]
    v_pk_fma_f32 v[116:117], v[116:117], v[124:125], v[132:133]
    v_pk_fma_f32 v[118:119], v[118:119], v[126:127], v[132:133]
    v_pk_fma_f32 v[120:121], v[120:121], v[128:129], v[132:133]
    v_pk_fma_f32 v[122:123], v[122:123], v[130:131], v[132:133]
    v_rcp_f32 v116, v116
    v_rcp_f32 v117, v117
    v_rcp_f32 v118, v118
    v_rcp_f32 v119, v119
    v_rcp_f32 v120, v120
    v_rcp_f32 v121, v121
    v_rcp_f32 v122, v122
    v_rcp_f32 v123, v123
    v_pk_fma_f32 v[116:117], v[116:117], v[134:135], v[136:137]
    v_pk_fma_f32 v[118:119], v[118:119], v[134:135], v[136:137]
    v_pk_fma_f32 v[120:121], v[120:121], v[134:135], v[136:137]
    v_pk_fma_f32 v[122:123], v[122:123], v[134:135], v[136:137]
    v_pk_mul_f32 v[116:117], v[116:117], v[36:37]
    v_pk_mul_f32 v[118:119], v[118:119], v[38:39]
    v_pk_mul_f32 v[120:121], v[120:121], v[40:41]
    v_pk_mul_f32 v[122:123], v[122:123], v[42:43]
    v_cvt_pk_bf16_f32 v148, v116, v117
    v_cvt_pk_bf16_f32 v149, v118, v119
    v_cvt_pk_bf16_f32 v150, v120, v121
    v_cvt_pk_bf16_f32 v151, v122, v123
    buffer_store_dwordx4 v[148:151], v9, s[28:31], s86 offen offset:3072 sc1
    v_pk_mul_f32 v[116:117], v[64:65], s[84:85]
    v_pk_mul_f32 v[118:119], v[66:67], s[84:85]
    v_pk_mul_f32 v[120:121], v[68:69], s[84:85]
    v_pk_mul_f32 v[122:123], v[70:71], s[84:85]
    v_exp_f32 v116, v116
    v_exp_f32 v117, v117
    v_exp_f32 v118, v118
    v_exp_f32 v119, v119
    v_exp_f32 v120, v120
    v_exp_f32 v121, v121
    v_exp_f32 v122, v122
    v_exp_f32 v123, v123
    v_pk_add_f32 v[124:125], v[116:117], v[132:133]
    v_pk_add_f32 v[126:127], v[118:119], v[132:133]
    v_pk_add_f32 v[128:129], v[120:121], v[132:133]
    v_pk_add_f32 v[130:131], v[122:123], v[132:133]
    v_pk_fma_f32 v[116:117], v[116:117], v[124:125], v[132:133]
    v_pk_fma_f32 v[118:119], v[118:119], v[126:127], v[132:133]
    v_pk_fma_f32 v[120:121], v[120:121], v[128:129], v[132:133]
    v_pk_fma_f32 v[122:123], v[122:123], v[130:131], v[132:133]
    v_rcp_f32 v116, v116
    v_rcp_f32 v117, v117
    v_rcp_f32 v118, v118
    v_rcp_f32 v119, v119
    v_rcp_f32 v120, v120
    v_rcp_f32 v121, v121
    v_rcp_f32 v122, v122
    v_rcp_f32 v123, v123
    v_pk_fma_f32 v[116:117], v[116:117], v[134:135], v[136:137]
    v_pk_fma_f32 v[118:119], v[118:119], v[134:135], v[136:137]
    v_pk_fma_f32 v[120:121], v[120:121], v[134:135], v[136:137]
    v_pk_fma_f32 v[122:123], v[122:123], v[134:135], v[136:137]
    v_pk_mul_f32 v[116:117], v[116:117], v[64:65]
    v_pk_mul_f32 v[118:119], v[118:119], v[66:67]
    v_pk_mul_f32 v[120:121], v[120:121], v[68:69]
    v_pk_mul_f32 v[122:123], v[122:123], v[70:71]
    v_cvt_pk_bf16_f32 v152, v116, v117
    v_cvt_pk_bf16_f32 v153, v118, v119
    v_cvt_pk_bf16_f32 v154, v120, v121
    v_cvt_pk_bf16_f32 v155, v122, v123
    buffer_store_dwordx4 v[152:155], v5, s[28:31], s86 offen offset:0 sc1
    v_pk_mul_f32 v[116:117], v[44:45], s[84:85]
    v_pk_mul_f32 v[118:119], v[46:47], s[84:85]
    v_pk_mul_f32 v[120:121], v[48:49], s[84:85]
    v_pk_mul_f32 v[122:123], v[50:51], s[84:85]
    v_exp_f32 v116, v116
    v_exp_f32 v117, v117
    v_exp_f32 v118, v118
    v_exp_f32 v119, v119
    v_exp_f32 v120, v120
    v_exp_f32 v121, v121
    v_exp_f32 v122, v122
    v_exp_f32 v123, v123
    v_pk_add_f32 v[124:125], v[116:117], v[132:133]
    v_pk_add_f32 v[126:127], v[118:119], v[132:133]
    v_pk_add_f32 v[128:129], v[120:121], v[132:133]
    v_pk_add_f32 v[130:131], v[122:123], v[132:133]
    v_pk_fma_f32 v[116:117], v[116:117], v[124:125], v[132:133]
    v_pk_fma_f32 v[118:119], v[118:119], v[126:127], v[132:133]
    v_pk_fma_f32 v[120:121], v[120:121], v[128:129], v[132:133]
    v_pk_fma_f32 v[122:123], v[122:123], v[130:131], v[132:133]
    v_rcp_f32 v116, v116
    v_rcp_f32 v117, v117
    v_rcp_f32 v118, v118
    v_rcp_f32 v119, v119
    v_rcp_f32 v120, v120
    v_rcp_f32 v121, v121
    v_rcp_f32 v122, v122
    v_rcp_f32 v123, v123
    v_pk_fma_f32 v[116:117], v[116:117], v[134:135], v[136:137]
    v_pk_fma_f32 v[118:119], v[118:119], v[134:135], v[136:137]
    v_pk_fma_f32 v[120:121], v[120:121], v[134:135], v[136:137]
    v_pk_fma_f32 v[122:123], v[122:123], v[134:135], v[136:137]
    v_pk_mul_f32 v[116:117], v[116:117], v[44:45]
    v_pk_mul_f32 v[118:119], v[118:119], v[46:47]
    v_pk_mul_f32 v[120:121], v[120:121], v[48:49]
    v_pk_mul_f32 v[122:123], v[122:123], v[50:51]
    v_cvt_pk_bf16_f32 v156, v116, v117
    v_cvt_pk_bf16_f32 v157, v118, v119
    v_cvt_pk_bf16_f32 v158, v120, v121
    v_cvt_pk_bf16_f32 v159, v122, v123
    buffer_store_dwordx4 v[156:159], v5, s[28:31], s86 offen offset:1024 sc1
    v_pk_mul_f32 v[116:117], v[72:73], s[84:85]
    v_pk_mul_f32 v[118:119], v[74:75], s[84:85]
    v_pk_mul_f32 v[120:121], v[76:77], s[84:85]
    v_pk_mul_f32 v[122:123], v[78:79], s[84:85]
    v_exp_f32 v116, v116
    v_exp_f32 v117, v117
    v_exp_f32 v118, v118
    v_exp_f32 v119, v119
    v_exp_f32 v120, v120
    v_exp_f32 v121, v121
    v_exp_f32 v122, v122
    v_exp_f32 v123, v123
    v_pk_add_f32 v[124:125], v[116:117], v[132:133]
    v_pk_add_f32 v[126:127], v[118:119], v[132:133]
    v_pk_add_f32 v[128:129], v[120:121], v[132:133]
    v_pk_add_f32 v[130:131], v[122:123], v[132:133]
    v_pk_fma_f32 v[116:117], v[116:117], v[124:125], v[132:133]
    v_pk_fma_f32 v[118:119], v[118:119], v[126:127], v[132:133]
    v_pk_fma_f32 v[120:121], v[120:121], v[128:129], v[132:133]
    v_pk_fma_f32 v[122:123], v[122:123], v[130:131], v[132:133]
    v_rcp_f32 v116, v116
    v_rcp_f32 v117, v117
    v_rcp_f32 v118, v118
    v_rcp_f32 v119, v119
    v_rcp_f32 v120, v120
    v_rcp_f32 v121, v121
    v_rcp_f32 v122, v122
    v_rcp_f32 v123, v123
    v_pk_fma_f32 v[116:117], v[116:117], v[134:135], v[136:137]
    v_pk_fma_f32 v[118:119], v[118:119], v[134:135], v[136:137]
    v_pk_fma_f32 v[120:121], v[120:121], v[134:135], v[136:137]
    v_pk_fma_f32 v[122:123], v[122:123], v[134:135], v[136:137]
    v_pk_mul_f32 v[116:117], v[116:117], v[72:73]
    v_pk_mul_f32 v[118:119], v[118:119], v[74:75]
    v_pk_mul_f32 v[120:121], v[120:121], v[76:77]
    v_pk_mul_f32 v[122:123], v[122:123], v[78:79]
    v_cvt_pk_bf16_f32 v160, v116, v117
    v_cvt_pk_bf16_f32 v161, v118, v119
    v_cvt_pk_bf16_f32 v162, v120, v121
    v_cvt_pk_bf16_f32 v163, v122, v123
    buffer_store_dwordx4 v[160:163], v5, s[28:31], s86 offen offset:2048 sc1
lw0:
    ds_read_b32 v8, v16 offset:96
    s_waitcnt lgkmcnt(0)
    v_cmp_ne_u32 vcc, 1, v8
    s_nop 1
    s_cbranch_vccnz lw0
lw1:
    ds_read_b32 v8, v16 offset:144
    s_waitcnt lgkmcnt(0)
    v_cmp_ne_u32 vcc, 1, v8
    s_nop 1
    s_cbranch_vccnz lw1
    ds_read_b64_tr_b16 a[0:1], v25 offset:43008
    ds_read_b64_tr_b16 a[2:3], v25 offset:46592
    ds_read_b64_tr_b16 a[4:5], v25 offset:43040
    ds_read_b64_tr_b16 a[6:7], v25 offset:46624
    ds_read_b64_tr_b16 a[8:9], v25 offset:43072
    ds_read_b64_tr_b16 a[10:11], v25 offset:46656
    ds_read_b64_tr_b16 a[12:13], v25 offset:43104
    ds_read_b64_tr_b16 a[14:15], v25 offset:46688
    ds_read_b64_tr_b16 a[16:17], v25 offset:43136
    ds_read_b64_tr_b16 a[18:19], v25 offset:46720
    ds_read_b64_tr_b16 a[20:21], v25 offset:43168
    ds_read_b64_tr_b16 a[22:23], v25 offset:46752
    ds_read_b64_tr_b16 a[24:25], v25 offset:43200
    ds_read_b64_tr_b16 a[26:27], v25 offset:46784
    s_setprio 0
    s_waitcnt lgkmcnt(10)
    v_mfma_f32_16x16x32_bf16 v[28:31], a[0:3], v[140:143], 0
    ds_read_b64_tr_b16 a[28:29], v25 offset:50176
    s_add_u32 s71, s75, 28672
    s_add_u32 m0, s72, 65536
    v_mfma_f32_16x16x32_bf16 v[56:59], a[0:3], v[144:147], 0
    s_mov_b32 exec_hi, 0xffffff
    buffer_load_dwordx4 v23, s[24:27], s71 offen lds
    s_mov_b32 exec_hi, -1
    v_mfma_f32_16x16x32_bf16 v[32:35], a[4:7], v[140:143], 0
    ds_read_b64_tr_b16 a[30:31], v25 offset:53760
    ds_read_b64_tr_b16 a[32:33], v25 offset:50208
    s_add_u32 s71, s75, 43008
    v_mfma_f32_16x16x32_bf16 v[60:63], a[4:7], v[144:147], 0
    ds_read_b64_tr_b16 a[34:35], v25 offset:53792
    s_add_u32 m0, s72, 69120
    s_waitcnt lgkmcnt(10)
    v_mfma_f32_16x16x32_bf16 v[36:39], a[8:11], v[140:143], 0
    s_mov_b32 exec_hi, 0xffffff
    buffer_load_dwordx4 v23, s[24:27], s71 offen lds
    s_mov_b32 exec_hi, -1
    v_mfma_f32_16x16x32_bf16 v[64:67], a[8:11], v[144:147], 0
    ds_read_b64_tr_b16 a[36:37], v25 offset:50240
    ds_read_b64_tr_b16 a[38:39], v25 offset:53824
    s_add_u32 s71, s75, 57344
    v_mfma_f32_16x16x32_bf16 v[40:43], a[12:15], v[140:143], 0
    ds_read_b64_tr_b16 a[40:41], v25 offset:50272
    s_add_u32 m0, s72, 72704
    v_mfma_f32_16x16x32_bf16 v[68:71], a[12:15], v[144:147], 0
    s_mov_b32 exec_hi, 0xffffff
    buffer_load_dwordx4 v23, s[24:27], s71 offen lds
    s_mov_b32 exec_hi, -1
    s_waitcnt lgkmcnt(9)
    v_mfma_f32_16x16x32_bf16 v[44:47], a[16:19], v[140:143], 0
    ds_read_b64_tr_b16 a[42:43], v25 offset:53856
    ds_read_b64_tr_b16 a[44:45], v25 offset:50304
    s_add_u32 s71, s75, 71680
    v_mfma_f32_16x16x32_bf16 v[72:75], a[16:19], v[144:147], 0
    ds_read_b64_tr_b16 a[46:47], v25 offset:53888
    s_add_u32 m0, s72, 76288
    v_mfma_f32_16x16x32_bf16 v[48:51], a[20:23], v[140:143], 0
    s_mov_b32 exec_hi, 0xffffff
    buffer_load_dwordx4 v23, s[24:27], s71 offen lds
    s_mov_b32 exec_hi, -1
    v_mfma_f32_16x16x32_bf16 v[76:79], a[20:23], v[144:147], 0
    ds_read_b64_tr_b16 a[48:49], v25 offset:50336
    ds_read_b64_tr_b16 a[50:51], v25 offset:53920
    s_waitcnt lgkmcnt(12)
    v_mfma_f32_16x16x32_bf16 v[52:55], a[24:27], v[140:143], 0
    ds_read_b64_tr_b16 a[52:53], v25 offset:50368
    s_add_u32 m0, s72, 0
    v_mfma_f32_16x16x32_bf16 v[80:83], a[24:27], v[144:147], 0
    ds_read_b64_tr_b16 a[54:55], v25 offset:53952
    s_waitcnt lgkmcnt(10)
    v_mfma_f32_16x16x32_bf16 v[28:31], a[28:31], v[148:151], v[28:31]
    s_mov_b32 exec_hi, 0xffffff
    buffer_load_dwordx4 v23, s[24:27], s78 offen lds
    s_mov_b32 exec_hi, -1
    v_mfma_f32_16x16x32_bf16 v[56:59], a[28:31], v[152:155], v[56:59]
    ds_read_b64_tr_b16 a[0:1], v24 offset:49152
    ds_read_b64_tr_b16 a[2:3], v24 offset:52736
    s_add_u32 m0, s72, 3584
    v_mfma_f32_16x16x32_bf16 v[32:35], a[32:35], v[148:151], v[32:35]
    ds_read_b64_tr_b16 a[4:5], v24 offset:49184
    v_mfma_f32_16x16x32_bf16 v[60:63], a[32:35], v[152:155], v[60:63]
    s_mov_b32 exec_hi, 0xffffff
    buffer_load_dwordx4 v23, s[24:27], s79 offen lds
    s_mov_b32 exec_hi, -1
    s_waitcnt lgkmcnt(9)
    v_mfma_f32_16x16x32_bf16 v[36:39], a[36:39], v[148:151], v[36:39]
    ds_read_b64_tr_b16 a[6:7], v24 offset:52768
    ds_read_b64_tr_b16 a[8:9], v24 offset:49216
    s_add_u32 m0, s72, 7168
    v_mfma_f32_16x16x32_bf16 v[64:67], a[36:39], v[152:155], v[64:67]
    ds_read_b64_tr_b16 a[10:11], v24 offset:52800
    v_mfma_f32_16x16x32_bf16 v[40:43], a[40:43], v[148:151], v[40:43]
    s_mov_b32 exec_hi, 0xffffff
    buffer_load_dwordx4 v23, s[24:27], s76 offen lds
    s_mov_b32 exec_hi, -1
    v_mfma_f32_16x16x32_bf16 v[68:71], a[40:43], v[152:155], v[68:71]
    ds_read_b64_tr_b16 a[12:13], v24 offset:49248
    ds_read_b64_tr_b16 a[14:15], v24 offset:52832
    s_waitcnt lgkmcnt(10)
    v_mfma_f32_16x16x32_bf16 v[44:47], a[44:47], v[148:151], v[44:47]
    ds_read_b64_tr_b16 a[16:17], v24 offset:49280
    s_add_u32 s71, s76, 14336
    s_add_u32 m0, s72, 10752
    v_mfma_f32_16x16x32_bf16 v[72:75], a[44:47], v[152:155], v[72:75]
    s_mov_b32 exec_hi, 0xffffff
    buffer_load_dwordx4 v23, s[24:27], s71 offen lds
    s_mov_b32 exec_hi, -1
    v_mfma_f32_16x16x32_bf16 v[48:51], a[48:51], v[148:151], v[48:51]
    ds_read_b64_tr_b16 a[18:19], v24 offset:52864
    ds_read_b64_tr_b16 a[20:21], v24 offset:49312
    s_add_u32 s71, s76, 28672
    v_mfma_f32_16x16x32_bf16 v[76:79], a[48:51], v[152:155], v[76:79]
    ds_read_b64_tr_b16 a[22:23], v24 offset:52896
    s_add_u32 m0, s72, 79872
    s_waitcnt lgkmcnt(12)
    v_mfma_f32_16x16x32_bf16 v[52:55], a[52:55], v[148:151], v[52:55]
    s_mov_b32 exec_hi, 0xffffff
    buffer_load_dwordx4 v23, s[24:27], s71 offen lds
    s_mov_b32 exec_hi, -1
    v_mfma_f32_16x16x32_bf16 v[80:83], a[52:55], v[152:155], v[80:83]
    ds_read_b64_tr_b16 a[24:25], v24 offset:49344
    ds_read_b64_tr_b16 a[26:27], v24 offset:52928
    s_add_u32 s71, s76, 43008
    s_waitcnt lgkmcnt(10)
    v_mfma_f32_16x16x32_bf16 v[28:31], a[0:3], v[156:159], v[28:31]
    ds_read_b64_tr_b16 a[28:29], v24 offset:56320
    s_add_u32 m0, s72, 83456
    v_mfma_f32_16x16x32_bf16 v[56:59], a[0:3], v[160:163], v[56:59]
    s_mov_b32 exec_hi, 0xffffff
    buffer_load_dwordx4 v23, s[24:27], s71 offen lds
    s_mov_b32 exec_hi, -1
    v_mfma_f32_16x16x32_bf16 v[32:35], a[4:7], v[156:159], v[32:35]
    ds_read_b64_tr_b16 a[30:31], v24 offset:59904
    ds_read_b64_tr_b16 a[32:33], v24 offset:56352
    s_add_u32 s71, s76, 57344
    v_mfma_f32_16x16x32_bf16 v[60:63], a[4:7], v[160:163], v[60:63]
    ds_read_b64_tr_b16 a[34:35], v24 offset:59936
    s_add_u32 m0, s72, 87040
    s_waitcnt lgkmcnt(10)
    v_mfma_f32_16x16x32_bf16 v[36:39], a[8:11], v[156:159], v[36:39]
    s_mov_b32 exec_hi, 0xffffff
    buffer_load_dwordx4 v23, s[24:27], s71 offen lds
    s_mov_b32 exec_hi, -1
    v_mfma_f32_16x16x32_bf16 v[64:67], a[8:11], v[160:163], v[64:67]
    ds_read_b64_tr_b16 a[36:37], v24 offset:56384
    ds_read_b64_tr_b16 a[38:39], v24 offset:59968
    s_add_u32 s71, s76, 71680
    v_mfma_f32_16x16x32_bf16 v[40:43], a[12:15], v[156:159], v[40:43]
    ds_read_b64_tr_b16 a[40:41], v24 offset:56416
    s_add_u32 m0, s72, 90624
    v_mfma_f32_16x16x32_bf16 v[68:71], a[12:15], v[160:163], v[68:71]
    s_mov_b32 exec_hi, 0xffffff
    buffer_load_dwordx4 v23, s[24:27], s71 offen lds
    s_mov_b32 exec_hi, -1
    s_waitcnt lgkmcnt(9)
    v_mfma_f32_16x16x32_bf16 v[44:47], a[16:19], v[156:159], v[44:47]
    ds_read_b64_tr_b16 a[42:43], v24 offset:60000
    ds_read_b64_tr_b16 a[44:45], v24 offset:56448
    s_add_u32 m0, s72, 94208
    v_mfma_f32_16x16x32_bf16 v[72:75], a[16:19], v[160:163], v[72:75]
    ds_read_b64_tr_b16 a[46:47], v24 offset:60032
    v_mfma_f32_16x16x32_bf16 v[48:51], a[20:23], v[156:159], v[48:51]
    s_mov_b32 exec_hi, 0xffffff
    buffer_load_dwordx4 v23, s[24:27], s77 offen lds
    s_mov_b32 exec_hi, -1
    v_mfma_f32_16x16x32_bf16 v[76:79], a[20:23], v[160:163], v[76:79]
    ds_read_b64_tr_b16 a[48:49], v24 offset:56480
    ds_read_b64_tr_b16 a[50:51], v24 offset:60064
    s_waitcnt lgkmcnt(12)
    v_mfma_f32_16x16x32_bf16 v[52:55], a[24:27], v[156:159], v[52:55]
    ds_read_b64_tr_b16 a[52:53], v24 offset:56512
    s_add_u32 s71, s77, 14336
    s_add_u32 m0, s72, 97792
    v_mfma_f32_16x16x32_bf16 v[80:83], a[24:27], v[160:163], v[80:83]
    ds_read_b64_tr_b16 a[54:55], v24 offset:60096
    s_waitcnt vmcnt(13)
    s_atomic_swap s7, s[28:29], s92
    s_mov_b32 exec_hi, 0xffffff
    buffer_load_dwordx4 v23, s[24:27], s71 offen lds
    s_mov_b32 exec_hi, -1
    s_mov_b32 s6, 0
    s_load_dword s64, s[28:29], s87 offset:7168 glc
    s_load_dword s65, s[28:29], s88 offset:7168 glc
    s_load_dword s66, s[28:29], s89 offset:7168 glc
    s_add_u32 m0, s72, 101376
    s_mov_b32 exec_hi, 0xffffff
    buffer_load_dwordx4 v23, s[24:27], s80 offen lds
    s_mov_b32 exec_hi, -1
    s_add_u32 m0, s72, 104960
    s_mov_b32 exec_hi, 0xffffff
    buffer_load_dwordx4 v23, s[24:27], s81 offen lds
    s_mov_b32 exec_hi, -1
    s_add_u32 s71, s77, 28672
    s_add_u32 m0, s72, 16384
    s_mov_b32 exec_hi, 0xffffff
    buffer_load_dwordx4 v23, s[24:27], s71 offen lds
    s_mov_b32 exec_hi, -1
    s_add_u32 s71, s77, 43008
    s_add_u32 m0, s72, 19968
    s_mov_b32 exec_hi, 0xffffff
    buffer_load_dwordx4 v23, s[24:27], s71 offen lds
    s_mov_b32 exec_hi, -1
    s_add_u32 s71, s77, 57344
    s_add_u32 m0, s72, 23552
    s_mov_b32 exec_hi, 0xffffff
    buffer_load_dwordx4 v23, s[24:27], s71 offen lds
    s_mov_b32 exec_hi, -1
    s_add_u32 s71, s77, 71680
    s_add_u32 m0, s72, 27136
    s_mov_b32 exec_hi, 0xffffff
    buffer_load_dwordx4 v23, s[24:27], s71 offen lds
    s_mov_b32 exec_hi, -1
    s_branch chk2
rty2:
    s_add_u32 s6, s6, 1
    s_cmp_ge_u32 s6, 500000
    s_cbranch_scc1 back2
    s_sleep 2
    s_load_dword s64, s[28:29], s87 offset:7168 glc
    s_load_dword s65, s[28:29], s88 offset:7168 glc
    s_load_dword s66, s[28:29], s89 offset:7168 glc
chk2:
    s_waitcnt lgkmcnt(0)
    s_xor_b32 s64, s64, s7
    s_xor_b32 s65, s65, s7
    s_or_b32 s64, s64, s65
    s_xor_b32 s66, s66, s7
    s_or_b32 s64, s64, s66
    s_cbranch_scc1 rty2
back2:
    buffer_load_dwordx4 v[84:87], v9, s[28:31], s87 offen offset:1024 sc1
    buffer_load_dwordx4 v[88:91], v9, s[28:31], s87 offen offset:2048 sc1
    buffer_load_dwordx4 v[92:95], v9, s[28:31], s87 offen offset:3072 sc1
    buffer_load_dwordx4 v[96:99], v5, s[28:31], s87 offen offset:0 sc1
    buffer_load_dwordx4 v[100:103], v5, s[28:31], s87 offen offset:1024 sc1
    buffer_load_dwordx4 v[104:107], v5, s[28:31], s87 offen offset:2048 sc1
    buffer_load_dwordx4 v[168:171], v9, s[28:31], s87 offen offset:0 sc1
    buffer_load_dwordx4 v[108:111], v9, s[28:31], s88 offen offset:1024 sc1
    buffer_load_dwordx4 v[112:115], v9, s[28:31], s88 offen offset:2048 sc1
    s_waitcnt vmcnt(9)
    ds_write_b32 v19, v17 offset:0
lw3:
    ds_read_b32 v8, v16 offset:0
    s_waitcnt lgkmcnt(0)
    v_cmp_ne_u32 vcc, 1, v8
    s_nop 1
    s_cbranch_vccnz lw3
    s_waitcnt vmcnt(7)
    s_waitcnt lgkmcnt(12)
    v_mfma_f32_16x16x32_bf16 v[28:31], a[28:31], v[84:87], v[28:31]
    buffer_load_dwordx4 v[116:119], v9, s[28:31], s88 offen offset:3072 sc1
    v_mfma_f32_16x16x32_bf16 v[56:59], a[28:31], v[88:91], v[56:59]
    ds_read_b64_tr_b16 a[0:1], v25 offset:0
    ds_read_b64_tr_b16 a[2:3], v25 offset:3584
    v_mfma_f32_16x16x32_bf16 v[32:35], a[32:35], v[84:87], v[32:35]
    buffer_load_dwordx4 v[120:123], v5, s[28:31], s88 offen offset:0 sc1
    v_mfma_f32_16x16x32_bf16 v[60:63], a[32:35], v[88:91], v[60:63]
    ds_read_b64_tr_b16 a[4:5], v25 offset:32
    ds_read_b64_tr_b16 a[6:7], v25 offset:3616
    s_waitcnt lgkmcnt(12)
    v_mfma_f32_16x16x32_bf16 v[36:39], a[36:39], v[84:87], v[36:39]
    buffer_load_dwordx4 v[124:127], v5, s[28:31], s88 offen offset:1024 sc1
    v_mfma_f32_16x16x32_bf16 v[64:67], a[36:39], v[88:91], v[64:67]
    buffer_load_dwordx4 v[128:131], v5, s[28:31], s88 offen offset:2048 sc1
    v_mfma_f32_16x16x32_bf16 v[40:43], a[40:43], v[84:87], v[40:43]
    buffer_load_dwordx4 v[132:135], v9, s[28:31], s89 offen offset:1024 sc1
    v_mfma_f32_16x16x32_bf16 v[68:71], a[40:43], v[88:91], v[68:71]
    buffer_load_dwordx4 v[136:139], v9, s[28:31], s89 offen offset:2048 sc1
    s_waitcnt lgkmcnt(8)
    v_mfma_f32_16x16x32_bf16 v[44:47], a[44:47], v[84:87], v[44:47]
    buffer_load_dwordx4 v[172:175], v9, s[28:31], s88 offen offset:0 sc1
    v_mfma_f32_16x16x32_bf16 v[72:75], a[44:47], v[88:91], v[72:75]
    ds_read_b64_tr_b16 a[8:9], v25 offset:64
    ds_read_b64_tr_b16 a[10:11], v25 offset:3648
    v_mfma_f32_16x16x32_bf16 v[48:51], a[48:51], v[84:87], v[48:51]
    ds_read_b64_tr_b16 a[12:13], v25 offset:96
    ds_read_b64_tr_b16 a[14:15], v25 offset:3680
    v_mfma_f32_16x16x32_bf16 v[76:79], a[48:51], v[88:91], v[76:79]
    ds_read_b64_tr_b16 a[16:17], v25 offset:128
    ds_read_b64_tr_b16 a[18:19], v25 offset:3712
    s_waitcnt lgkmcnt(12)
    v_mfma_f32_16x16x32_bf16 v[52:55], a[52:55], v[84:87], v[52:55]
    ds_read_b64_tr_b16 a[20:21], v25 offset:160
    ds_read_b64_tr_b16 a[22:23], v25 offset:3744
    v_mfma_f32_16x16x32_bf16 v[80:83], a[52:55], v[88:91], v[80:83]
    ds_read_b64_tr_b16 a[24:25], v25 offset:192
    ds_read_b64_tr_b16 a[26:27], v25 offset:3776
    s_waitcnt vmcnt(12)
    s_waitcnt lgkmcnt(10)
    v_mfma_f32_16x16x32_bf16 v[28:31], a[0:3], v[92:95], v[28:31]
    buffer_load_dwordx4 v[176:179], v9, s[28:31], s89 offen offset:0 sc1
    v_mfma_f32_16x16x32_bf16 v[56:59], a[0:3], v[96:99], v[56:59]
    ds_read_b64_tr_b16 a[28:29], v25 offset:7168
    ds_read_b64_tr_b16 a[30:31], v25 offset:10752
    v_mfma_f32_16x16x32_bf16 v[32:35], a[4:7], v[92:95], v[32:35]
    buffer_load_dwordx4 v[140:143], v9, s[28:31], s89 offen offset:3072 sc1
    v_mfma_f32_16x16x32_bf16 v[60:63], a[4:7], v[96:99], v[60:63]
    ds_read_b64_tr_b16 a[32:33], v25 offset:7200
    ds_read_b64_tr_b16 a[34:35], v25 offset:10784
    s_waitcnt lgkmcnt(10)
    v_mfma_f32_16x16x32_bf16 v[36:39], a[8:11], v[92:95], v[36:39]
    buffer_load_dwordx4 v[144:147], v5, s[28:31], s89 offen offset:0 sc1
    v_mfma_f32_16x16x32_bf16 v[64:67], a[8:11], v[96:99], v[64:67]
    buffer_load_dwordx4 v[148:151], v5, s[28:31], s89 offen offset:1024 sc1
    v_mfma_f32_16x16x32_bf16 v[40:43], a[12:15], v[92:95], v[40:43]
    buffer_load_dwordx4 v[152:155], v5, s[28:31], s89 offen offset:2048 sc1
    v_mfma_f32_16x16x32_bf16 v[68:71], a[12:15], v[96:99], v[68:71]
    ds_read_b64_tr_b16 a[36:37], v25 offset:7232
    ds_read_b64_tr_b16 a[38:39], v25 offset:10816
    s_waitcnt lgkmcnt(8)
    v_mfma_f32_16x16x32_bf16 v[44:47], a[16:19], v[92:95], v[44:47]
    ds_read_b64_tr_b16 a[40:41], v25 offset:7264
    ds_read_b64_tr_b16 a[42:43], v25 offset:10848
    v_mfma_f32_16x16x32_bf16 v[72:75], a[16:19], v[96:99], v[72:75]
    ds_read_b64_tr_b16 a[44:45], v25 offset:7296
    ds_read_b64_tr_b16 a[46:47], v25 offset:10880
    v_mfma_f32_16x16x32_bf16 v[48:51], a[20:23], v[92:95], v[48:51]
    ds_read_b64_tr_b16 a[48:49], v25 offset:7328
    v_mfma_f32_16x16x32_bf16 v[76:79], a[20:23], v[96:99], v[76:79]
    ds_read_b64_tr_b16 a[50:51], v25 offset:10912
    s_waitcnt lgkmcnt(12)
    v_mfma_f32_16x16x32_bf16 v[52:55], a[24:27], v[92:95], v[52:55]
    ds_read_b64_tr_b16 a[52:53], v25 offset:7360
    v_mfma_f32_16x16x32_bf16 v[80:83], a[24:27], v[96:99], v[80:83]
    ds_read_b64_tr_b16 a[54:55], v25 offset:10944
    s_waitcnt vmcnt(15)
    s_waitcnt lgkmcnt(10)
    v_mfma_f32_16x16x32_bf16 v[28:31], a[28:31], v[100:103], v[28:31]
    ds_read_b64_tr_b16 a[0:1], v24 offset:0
    v_mfma_f32_16x16x32_bf16 v[56:59], a[28:31], v[104:107], v[56:59]
    ds_read_b64_tr_b16 a[2:3], v24 offset:3584
    v_mfma_f32_16x16x32_bf16 v[32:35], a[32:35], v[100:103], v[32:35]
    ds_read_b64_tr_b16 a[4:5], v24 offset:32
    v_mfma_f32_16x16x32_bf16 v[60:63], a[32:35], v[104:107], v[60:63]
    ds_read_b64_tr_b16 a[6:7], v24 offset:3616
    s_waitcnt lgkmcnt(10)
    v_mfma_f32_16x16x32_bf16 v[36:39], a[36:39], v[100:103], v[36:39]
    ds_read_b64_tr_b16 a[8:9], v24 offset:64
    s_waitcnt vmcnt(14)
    v_accvgpr_write_b32 a56, v164
    v_mfma_f32_16x16x32_bf16 v[64:67], a[36:39], v[104:107], v[64:67]
    ds_read_b64_tr_b16 a[10:11], v24 offset:3648
    v_accvgpr_write_b32 a57, v165
    v_mfma_f32_16x16x32_bf16 v[40:43], a[40:43], v[100:103], v[40:43]
    ds_read_b64_tr_b16 a[12:13], v24 offset:96
    v_accvgpr_write_b32 a58, v168
    v_mfma_f32_16x16x32_bf16 v[68:71], a[40:43], v[104:107], v[68:71]
    ds_read_b64_tr_b16 a[14:15], v24 offset:3680
    v_accvgpr_write_b32 a59, v169
    s_waitcnt lgkmcnt(10)
    v_mfma_f32_16x16x32_bf16 v[44:47], a[44:47], v[100:103], v[44:47]
    ds_read_b64_tr_b16 a[16:17], v24 offset:128
    v_accvgpr_write_b32 a60, v166
    v_mfma_f32_16x16x32_bf16 v[72:75], a[44:47], v[104:107], v[72:75]
    ds_read_b64_tr_b16 a[18:19], v24 offset:3712
    v_accvgpr_write_b32 a61, v167
    v_mfma_f32_16x16x32_bf16 v[48:51], a[48:51], v[100:103], v[48:51]
    ds_read_b64_tr_b16 a[20:21], v24 offset:160
    v_accvgpr_write_b32 a62, v170
    v_mfma_f32_16x16x32_bf16 v[76:79], a[48:51], v[104:107], v[76:79]
    ds_read_b64_tr_b16 a[22:23], v24 offset:3744
    v_accvgpr_write_b32 a63, v171
    s_waitcnt lgkmcnt(12)
    v_mfma_f32_16x16x32_bf16 v[52:55], a[52:55], v[100:103], v[52:55]
    ds_read_b64_tr_b16 a[24:25], v24 offset:192
    v_mfma_f32_16x16x32_bf16 v[80:83], a[52:55], v[104:107], v[80:83]
    ds_read_b64_tr_b16 a[26:27], v24 offset:3776
    s_waitcnt lgkmcnt(10)
    v_mfma_f32_16x16x32_bf16 v[28:31], a[0:3], a[56:59], v[28:31]
    ds_read_b64_tr_b16 a[28:29], v24 offset:7168
    v_mfma_f32_16x16x32_bf16 v[56:59], a[0:3], a[60:63], v[56:59]
    ds_read_b64_tr_b16 a[30:31], v24 offset:10752
    v_mfma_f32_16x16x32_bf16 v[32:35], a[4:7], a[56:59], v[32:35]
    ds_read_b64_tr_b16 a[32:33], v24 offset:7200
    v_mfma_f32_16x16x32_bf16 v[60:63], a[4:7], a[60:63], v[60:63]
    ds_read_b64_tr_b16 a[34:35], v24 offset:10784
    s_waitcnt lgkmcnt(10)
    v_mfma_f32_16x16x32_bf16 v[36:39], a[8:11], a[56:59], v[36:39]
    ds_read_b64_tr_b16 a[36:37], v24 offset:7232
    v_mfma_f32_16x16x32_bf16 v[64:67], a[8:11], a[60:63], v[64:67]
    ds_read_b64_tr_b16 a[38:39], v24 offset:10816
    v_mfma_f32_16x16x32_bf16 v[40:43], a[12:15], a[56:59], v[40:43]
    ds_read_b64_tr_b16 a[40:41], v24 offset:7264
    v_mfma_f32_16x16x32_bf16 v[68:71], a[12:15], a[60:63], v[68:71]
    ds_read_b64_tr_b16 a[42:43], v24 offset:10848
    s_waitcnt lgkmcnt(10)
    v_mfma_f32_16x16x32_bf16 v[44:47], a[16:19], a[56:59], v[44:47]
    ds_read_b64_tr_b16 a[44:45], v24 offset:7296
    v_mfma_f32_16x16x32_bf16 v[72:75], a[16:19], a[60:63], v[72:75]
    ds_read_b64_tr_b16 a[46:47], v24 offset:10880
    v_mfma_f32_16x16x32_bf16 v[48:51], a[20:23], a[56:59], v[48:51]
    ds_read_b64_tr_b16 a[48:49], v24 offset:7328
    v_mfma_f32_16x16x32_bf16 v[76:79], a[20:23], a[60:63], v[76:79]
    ds_read_b64_tr_b16 a[50:51], v24 offset:10912
    s_waitcnt lgkmcnt(12)
    v_mfma_f32_16x16x32_bf16 v[52:55], a[24:27], a[56:59], v[52:55]
    ds_read_b64_tr_b16 a[52:53], v24 offset:7360
    v_mfma_f32_16x16x32_bf16 v[80:83], a[24:27], a[60:63], v[80:83]
    ds_read_b64_tr_b16 a[54:55], v24 offset:10944
    s_waitcnt vmcnt(12)
    s_waitcnt lgkmcnt(10)
    v_mfma_f32_16x16x32_bf16 v[28:31], a[28:31], v[108:111], v[28:31]
    ds_read_b64_tr_b16 a[0:1], v25 offset:14336
    v_mfma_f32_16x16x32_bf16 v[56:59], a[28:31], v[112:115], v[56:59]
    ds_read_b64_tr_b16 a[2:3], v25 offset:17920
    v_mfma_f32_16x16x32_bf16 v[32:35], a[32:35], v[108:111], v[32:35]
    ds_read_b64_tr_b16 a[4:5], v25 offset:14368
    v_mfma_f32_16x16x32_bf16 v[60:63], a[32:35], v[112:115], v[60:63]
    ds_read_b64_tr_b16 a[6:7], v25 offset:17952
    s_waitcnt lgkmcnt(10)
    v_mfma_f32_16x16x32_bf16 v[36:39], a[36:39], v[108:111], v[36:39]
    ds_read_b64_tr_b16 a[8:9], v25 offset:14400
    v_mfma_f32_16x16x32_bf16 v[64:67], a[36:39], v[112:115], v[64:67]
    ds_read_b64_tr_b16 a[10:11], v25 offset:17984
    v_mfma_f32_16x16x32_bf16 v[40:43], a[40:43], v[108:111], v[40:43]
    ds_read_b64_tr_b16 a[12:13], v25 offset:14432
    v_mfma_f32_16x16x32_bf16 v[68:71], a[40:43], v[112:115], v[68:71]
    ds_read_b64_tr_b16 a[14:15], v25 offset:18016
    s_waitcnt lgkmcnt(10)
    v_mfma_f32_16x16x32_bf16 v[44:47], a[44:47], v[108:111], v[44:47]
    ds_read_b64_tr_b16 a[16:17], v25 offset:14464
    v_mfma_f32_16x16x32_bf16 v[72:75], a[44:47], v[112:115], v[72:75]
    ds_read_b64_tr_b16 a[18:19], v25 offset:18048
    v_mfma_f32_16x16x32_bf16 v[48:51], a[48:51], v[108:111], v[48:51]
    ds_read_b64_tr_b16 a[20:21], v25 offset:14496
    v_mfma_f32_16x16x32_bf16 v[76:79], a[48:51], v[112:115], v[76:79]
    ds_read_b64_tr_b16 a[22:23], v25 offset:18080
    s_waitcnt lgkmcnt(12)
    v_mfma_f32_16x16x32_bf16 v[52:55], a[52:55], v[108:111], v[52:55]
    ds_read_b64_tr_b16 a[24:25], v25 offset:14528
    v_mfma_f32_16x16x32_bf16 v[80:83], a[52:55], v[112:115], v[80:83]
    ds_read_b64_tr_b16 a[26:27], v25 offset:18112
    s_waitcnt vmcnt(10)
    s_waitcnt lgkmcnt(10)
    v_mfma_f32_16x16x32_bf16 v[28:31], a[0:3], v[116:119], v[28:31]
    ds_read_b64_tr_b16 a[28:29], v25 offset:21504
    v_mfma_f32_16x16x32_bf16 v[56:59], a[0:3], v[120:123], v[56:59]
    ds_read_b64_tr_b16 a[30:31], v25 offset:25088
    v_mfma_f32_16x16x32_bf16 v[32:35], a[4:7], v[116:119], v[32:35]
    ds_read_b64_tr_b16 a[32:33], v25 offset:21536
    v_mfma_f32_16x16x32_bf16 v[60:63], a[4:7], v[120:123], v[60:63]
    ds_read_b64_tr_b16 a[34:35], v25 offset:25120
    s_waitcnt lgkmcnt(10)
    v_mfma_f32_16x16x32_bf16 v[36:39], a[8:11], v[116:119], v[36:39]
    ds_read_b64_tr_b16 a[36:37], v25 offset:21568
    v_mfma_f32_16x16x32_bf16 v[64:67], a[8:11], v[120:123], v[64:67]
    ds_read_b64_tr_b16 a[38:39], v25 offset:25152
    v_mfma_f32_16x16x32_bf16 v[40:43], a[12:15], v[116:119], v[40:43]
    ds_read_b64_tr_b16 a[40:41], v25 offset:21600
    v_mfma_f32_16x16x32_bf16 v[68:71], a[12:15], v[120:123], v[68:71]
    ds_read_b64_tr_b16 a[42:43], v25 offset:25184
    s_waitcnt lgkmcnt(10)
    v_mfma_f32_16x16x32_bf16 v[44:47], a[16:19], v[116:119], v[44:47]
    ds_read_b64_tr_b16 a[44:45], v25 offset:21632
    v_mfma_f32_16x16x32_bf16 v[72:75], a[16:19], v[120:123], v[72:75]
    ds_read_b64_tr_b16 a[46:47], v25 offset:25216
    v_mfma_f32_16x16x32_bf16 v[48:51], a[20:23], v[116:119], v[48:51]
    ds_read_b64_tr_b16 a[48:49], v25 offset:21664
    v_mfma_f32_16x16x32_bf16 v[76:79], a[20:23], v[120:123], v[76:79]
    ds_read_b64_tr_b16 a[50:51], v25 offset:25248
    s_waitcnt lgkmcnt(12)
    v_mfma_f32_16x16x32_bf16 v[52:55], a[24:27], v[116:119], v[52:55]
    ds_read_b64_tr_b16 a[52:53], v25 offset:21696
    v_mfma_f32_16x16x32_bf16 v[80:83], a[24:27], v[120:123], v[80:83]
    ds_read_b64_tr_b16 a[54:55], v25 offset:25280
    s_waitcnt vmcnt(8)
    s_waitcnt lgkmcnt(10)
    v_mfma_f32_16x16x32_bf16 v[28:31], a[28:31], v[124:127], v[28:31]
    ds_read_b64_tr_b16 a[0:1], v25 offset:28672
    v_mfma_f32_16x16x32_bf16 v[56:59], a[28:31], v[128:131], v[56:59]
    ds_read_b64_tr_b16 a[2:3], v25 offset:32256
    v_mfma_f32_16x16x32_bf16 v[32:35], a[32:35], v[124:127], v[32:35]
    ds_read_b64_tr_b16 a[4:5], v25 offset:35840
    v_mfma_f32_16x16x32_bf16 v[60:63], a[32:35], v[128:131], v[60:63]
    ds_read_b64_tr_b16 a[6:7], v25 offset:39424
    s_waitcnt lgkmcnt(10)
    v_mfma_f32_16x16x32_bf16 v[36:39], a[36:39], v[124:127], v[36:39]
    ds_read_b64_tr_b16 a[8:9], v24 offset:16384
    s_waitcnt vmcnt(4)
    v_accvgpr_write_b32 a64, v172
    v_mfma_f32_16x16x32_bf16 v[64:67], a[36:39], v[128:131], v[64:67]
    ds_read_b64_tr_b16 a[10:11], v24 offset:19968
    v_accvgpr_write_b32 a65, v173
    v_mfma_f32_16x16x32_bf16 v[40:43], a[40:43], v[124:127], v[40:43]
    ds_read_b64_tr_b16 a[12:13], v24 offset:23552
    v_accvgpr_write_b32 a66, v176
    v_mfma_f32_16x16x32_bf16 v[68:71], a[40:43], v[128:131], v[68:71]
    ds_read_b64_tr_b16 a[14:15], v24 offset:27136
    v_accvgpr_write_b32 a67, v177
    s_waitcnt lgkmcnt(10)
    v_mfma_f32_16x16x32_bf16 v[44:47], a[44:47], v[124:127], v[44:47]
    ds_read_b64_tr_b16 a[16:17], v25 offset:28704
    v_accvgpr_write_b32 a68, v174
    v_mfma_f32_16x16x32_bf16 v[72:75], a[44:47], v[128:131], v[72:75]
    ds_read_b64_tr_b16 a[18:19], v25 offset:32288
    v_accvgpr_write_b32 a69, v175
    v_mfma_f32_16x16x32_bf16 v[48:51], a[48:51], v[124:127], v[48:51]
    ds_read_b64_tr_b16 a[20:21], v25 offset:35872
    v_accvgpr_write_b32 a70, v178
    v_mfma_f32_16x16x32_bf16 v[76:79], a[48:51], v[128:131], v[76:79]
    ds_read_b64_tr_b16 a[22:23], v25 offset:39456
    v_accvgpr_write_b32 a71, v179
    s_waitcnt lgkmcnt(12)
    v_mfma_f32_16x16x32_bf16 v[52:55], a[52:55], v[124:127], v[52:55]
    ds_read_b64_tr_b16 a[24:25], v24 offset:16416
    v_mfma_f32_16x16x32_bf16 v[80:83], a[52:55], v[128:131], v[80:83]
    ds_read_b64_tr_b16 a[26:27], v24 offset:20000
    s_cmp_eq_u32 s8, s48
    s_cselect_b32 s90, 0x40000000, s90
    s_waitcnt vmcnt(0)
    s_waitcnt lgkmcnt(10)
    v_mfma_f32_16x16x32_bf16 v[28:31], a[0:3], v[132:135], v[28:31]
    ds_read_b64_tr_b16 a[28:29], v24 offset:23584
    v_mfma_f32_16x16x32_bf16 v[56:59], a[0:3], v[136:139], v[56:59]
    ds_read_b64_tr_b16 a[30:31], v24 offset:27168
    v_mfma_f32_16x16x32_bf16 v[28:31], a[4:7], a[64:67], v[28:31]
    ds_read_b64_tr_b16 a[32:33], v25 offset:28736
    v_mfma_f32_16x16x32_bf16 v[56:59], a[4:7], a[68:71], v[56:59]
    ds_read_b64_tr_b16 a[34:35], v25 offset:32320
    s_waitcnt lgkmcnt(10)
    v_mfma_f32_16x16x32_bf16 v[28:31], a[8:11], v[140:143], v[28:31]
    ds_read_b64_tr_b16 a[36:37], v25 offset:35904
    v_mfma_f32_16x16x32_bf16 v[56:59], a[8:11], v[144:147], v[56:59]
    ds_read_b64_tr_b16 a[38:39], v25 offset:39488
    v_mfma_f32_16x16x32_bf16 v[28:31], a[12:15], v[148:151], v[28:31]
    ds_read_b64_tr_b16 a[40:41], v24 offset:16448
    v_mfma_f32_16x16x32_bf16 v[56:59], a[12:15], v[152:155], v[56:59]
    ds_read_b64_tr_b16 a[42:43], v24 offset:20032
    s_waitcnt lgkmcnt(10)
    v_mfma_f32_16x16x32_bf16 v[32:35], a[16:19], v[132:135], v[32:35]
    ds_read_b64_tr_b16 a[44:45], v24 offset:23616
    v_mfma_f32_16x16x32_bf16 v[60:63], a[16:19], v[136:139], v[60:63]
    ds_read_b64_tr_b16 a[46:47], v24 offset:27200
    v_mfma_f32_16x16x32_bf16 v[32:35], a[20:23], a[64:67], v[32:35]
    ds_read_b64_tr_b16 a[48:49], v25 offset:28768
    v_mfma_f32_16x16x32_bf16 v[60:63], a[20:23], a[68:71], v[60:63]
    ds_read_b64_tr_b16 a[50:51], v25 offset:32352
    v_cvt_pk_bf16_f32 v28, v28, v29
    s_waitcnt lgkmcnt(10)
    v_mfma_f32_16x16x32_bf16 v[32:35], a[24:27], v[140:143], v[32:35]
    ds_read_b64_tr_b16 a[52:53], v25 offset:35936
    v_cvt_pk_bf16_f32 v29, v30, v31
    v_mfma_f32_16x16x32_bf16 v[60:63], a[24:27], v[144:147], v[60:63]
    ds_read_b64_tr_b16 a[54:55], v25 offset:39520
    v_cvt_pk_bf16_f32 v30, v56, v57
    v_mfma_f32_16x16x32_bf16 v[32:35], a[28:31], v[148:151], v[32:35]
    ds_read_b64_tr_b16 a[0:1], v24 offset:16480
    v_cvt_pk_bf16_f32 v31, v58, v59
    v_mfma_f32_16x16x32_bf16 v[60:63], a[28:31], v[152:155], v[60:63]
    ds_read_b64_tr_b16 a[2:3], v24 offset:20064
    buffer_store_dwordx4 v[28:31], v9, s[28:31], s90 offen offset:0 sc1
    s_waitcnt lgkmcnt(10)
    v_mfma_f32_16x16x32_bf16 v[36:39], a[32:35], v[132:135], v[36:39]
    ds_read_b64_tr_b16 a[4:5], v24 offset:23648
    v_mfma_f32_16x16x32_bf16 v[64:67], a[32:35], v[136:139], v[64:67]
    ds_read_b64_tr_b16 a[6:7], v24 offset:27232
    v_mfma_f32_16x16x32_bf16 v[36:39], a[36:39], a[64:67], v[36:39]
    ds_read_b64_tr_b16 a[8:9], v25 offset:28800
    v_mfma_f32_16x16x32_bf16 v[64:67], a[36:39], a[68:71], v[64:67]
    ds_read_b64_tr_b16 a[10:11], v25 offset:32384
    v_cvt_pk_bf16_f32 v32, v32, v33
    s_waitcnt lgkmcnt(10)
    v_mfma_f32_16x16x32_bf16 v[36:39], a[40:43], v[140:143], v[36:39]
    ds_read_b64_tr_b16 a[12:13], v25 offset:35968
    v_cvt_pk_bf16_f32 v33, v34, v35
    v_mfma_f32_16x16x32_bf16 v[64:67], a[40:43], v[144:147], v[64:67]
    ds_read_b64_tr_b16 a[14:15], v25 offset:39552
    v_cvt_pk_bf16_f32 v34, v60, v61
    v_mfma_f32_16x16x32_bf16 v[36:39], a[44:47], v[148:151], v[36:39]
    ds_read_b64_tr_b16 a[16:17], v24 offset:16512
    v_cvt_pk_bf16_f32 v35, v62, v63
    v_mfma_f32_16x16x32_bf16 v[64:67], a[44:47], v[152:155], v[64:67]
    ds_read_b64_tr_b16 a[18:19], v24 offset:20096
    buffer_store_dwordx4 v[32:35], v9, s[28:31], s90 offen offset:1024 sc1
    s_waitcnt lgkmcnt(10)
    v_mfma_f32_16x16x32_bf16 v[40:43], a[48:51], v[132:135], v[40:43]
    ds_read_b64_tr_b16 a[20:21], v24 offset:23680
    v_mfma_f32_16x16x32_bf16 v[68:71], a[48:51], v[136:139], v[68:71]
    ds_read_b64_tr_b16 a[22:23], v24 offset:27264
    v_mfma_f32_16x16x32_bf16 v[40:43], a[52:55], a[64:67], v[40:43]
    ds_read_b64_tr_b16 a[24:25], v25 offset:28832
    v_mfma_f32_16x16x32_bf16 v[68:71], a[52:55], a[68:71], v[68:71]
    ds_read_b64_tr_b16 a[26:27], v25 offset:32416
    v_cvt_pk_bf16_f32 v36, v36, v37
    s_waitcnt lgkmcnt(10)
    v_mfma_f32_16x16x32_bf16 v[40:43], a[0:3], v[140:143], v[40:43]
    ds_read_b64_tr_b16 a[28:29], v25 offset:36000
    v_cvt_pk_bf16_f32 v37, v38, v39
    v_mfma_f32_16x16x32_bf16 v[68:71], a[0:3], v[144:147], v[68:71]
    ds_read_b64_tr_b16 a[30:31], v25 offset:39584
    v_cvt_pk_bf16_f32 v38, v64, v65
    v_mfma_f32_16x16x32_bf16 v[40:43], a[4:7], v[148:151], v[40:43]
    ds_read_b64_tr_b16 a[32:33], v24 offset:16544
    v_cvt_pk_bf16_f32 v39, v66, v67
    v_mfma_f32_16x16x32_bf16 v[68:71], a[4:7], v[152:155], v[68:71]
    ds_read_b64_tr_b16 a[34:35], v24 offset:20128
    buffer_store_dwordx4 v[36:39], v9, s[28:31], s90 offen offset:2048 sc1
    s_waitcnt lgkmcnt(10)
    v_mfma_f32_16x16x32_bf16 v[44:47], a[8:11], v[132:135], v[44:47]
    ds_read_b64_tr_b16 a[36:37], v24 offset:23712
    v_mfma_f32_16x16x32_bf16 v[72:75], a[8:11], v[136:139], v[72:75]
    ds_read_b64_tr_b16 a[38:39], v24 offset:27296
    v_mfma_f32_16x16x32_bf16 v[44:47], a[12:15], a[64:67], v[44:47]
    ds_read_b64_tr_b16 a[40:41], v25 offset:28864
    v_mfma_f32_16x16x32_bf16 v[72:75], a[12:15], a[68:71], v[72:75]
    ds_read_b64_tr_b16 a[42:43], v25 offset:32448
    v_cvt_pk_bf16_f32 v40, v40, v41
    s_waitcnt lgkmcnt(10)
    v_mfma_f32_16x16x32_bf16 v[44:47], a[16:19], v[140:143], v[44:47]
    ds_read_b64_tr_b16 a[44:45], v25 offset:36032
    v_cvt_pk_bf16_f32 v41, v42, v43
    v_mfma_f32_16x16x32_bf16 v[72:75], a[16:19], v[144:147], v[72:75]
    ds_read_b64_tr_b16 a[46:47], v25 offset:39616
    v_cvt_pk_bf16_f32 v42, v68, v69
    v_mfma_f32_16x16x32_bf16 v[44:47], a[20:23], v[148:151], v[44:47]
    ds_read_b64_tr_b16 a[48:49], v24 offset:16576
    v_cvt_pk_bf16_f32 v43, v70, v71
    v_mfma_f32_16x16x32_bf16 v[72:75], a[20:23], v[152:155], v[72:75]
    ds_read_b64_tr_b16 a[50:51], v24 offset:20160
    buffer_store_dwordx4 v[40:43], v9, s[28:31], s90 offen offset:3072 sc1
    s_waitcnt lgkmcnt(10)
    v_mfma_f32_16x16x32_bf16 v[48:51], a[24:27], v[132:135], v[48:51]
    ds_read_b64_tr_b16 a[52:53], v24 offset:23744
    v_mfma_f32_16x16x32_bf16 v[76:79], a[24:27], v[136:139], v[76:79]
    ds_read_b64_tr_b16 a[54:55], v24 offset:27328
    v_mfma_f32_16x16x32_bf16 v[48:51], a[28:31], a[64:67], v[48:51]
    v_mfma_f32_16x16x32_bf16 v[76:79], a[28:31], a[68:71], v[76:79]
    v_cvt_pk_bf16_f32 v44, v44, v45
    v_cvt_pk_bf16_f32 v45, v46, v47
    s_waitcnt lgkmcnt(8)
    v_mfma_f32_16x16x32_bf16 v[48:51], a[32:35], v[140:143], v[48:51]
    v_cvt_pk_bf16_f32 v46, v72, v73
    v_cvt_pk_bf16_f32 v47, v74, v75
    v_mfma_f32_16x16x32_bf16 v[76:79], a[32:35], v[144:147], v[76:79]
    buffer_store_dwordx4 v[44:47], v5, s[28:31], s90 offen offset:0 sc1
    v_mfma_f32_16x16x32_bf16 v[48:51], a[36:39], v[148:151], v[48:51]
    v_mfma_f32_16x16x32_bf16 v[76:79], a[36:39], v[152:155], v[76:79]
    s_waitcnt lgkmcnt(4)
    v_mfma_f32_16x16x32_bf16 v[52:55], a[40:43], v[132:135], v[52:55]
    v_mfma_f32_16x16x32_bf16 v[80:83], a[40:43], v[136:139], v[80:83]
    v_mfma_f32_16x16x32_bf16 v[52:55], a[44:47], a[64:67], v[52:55]
    v_mfma_f32_16x16x32_bf16 v[80:83], a[44:47], a[68:71], v[80:83]
    s_nop 1
    v_cvt_pk_bf16_f32 v48, v48, v49
    v_cvt_pk_bf16_f32 v49, v50, v51
    s_waitcnt lgkmcnt(0)
    v_mfma_f32_16x16x32_bf16 v[52:55], a[48:51], v[140:143], v[52:55]
    v_cvt_pk_bf16_f32 v50, v76, v77
    v_cvt_pk_bf16_f32 v51, v78, v79
    v_mfma_f32_16x16x32_bf16 v[80:83], a[48:51], v[144:147], v[80:83]
    buffer_store_dwordx4 v[48:51], v5, s[28:31], s90 offen offset:1024 sc1
    v_mfma_f32_16x16x32_bf16 v[52:55], a[52:55], v[148:151], v[52:55]
    v_mfma_f32_16x16x32_bf16 v[80:83], a[52:55], v[152:155], v[80:83]
    s_nop 6
    v_cvt_pk_bf16_f32 v52, v52, v53
    v_cvt_pk_bf16_f32 v53, v54, v55
    v_cvt_pk_bf16_f32 v54, v80, v81
    v_cvt_pk_bf16_f32 v55, v82, v83
    buffer_store_dwordx4 v[52:55], v5, s[28:31], s90 offen offset:2048 sc1
    s_cmp_lg_u32 s8, s48
    s_cbranch_scc1 L_partd
    ds_write_b128 v7, v[28:31] offset:0
    ds_write_b128 v7, v[32:35] offset:1024
    ds_write_b128 v7, v[36:39] offset:2048
    ds_write_b128 v7, v[40:43] offset:3072
    ds_write_b128 v7, v[44:47] offset:4096
    ds_write_b128 v7, v[48:51] offset:5120
    ds_write_b128 v7, v[52:55] offset:6144
L_partd:
    ds_write_b32 v19, v17 offset:80
    s_mul_i32 s56, s52, 116736
    s_mul_i32 s3, s49, 29184
    s_add_u32 s56, s56, s3
    s_add_u32 s56, s56, 0x801c00
    s_mul_i32 s57, s52, 116736
    s_mul_i32 s3, s49, 29184
    s_add_u32 s57, s57, s3
    s_mul_i32 s3, s8, 2048
    s_add_u32 s57, s57, s3
    s_add_u32 s57, s57, 0x800000
    s_cmp_eq_u32 s8, 3
    s_cselect_b32 s5, 0, 2048
    s_add_u32 s4, s48, 1
    s_and_b32 s4, s4, 3
    s_mul_i32 s74, s4, 7296
    s_add_u32 s74, s74, s57
    s_mul_i32 s86, s4, 7296
    s_add_u32 s86, s86, s56
    s_add_u32 s4, s48, 2
    s_and_b32 s4, s4, 3
    s_mul_i32 s75, s4, 7296
    s_add_u32 s75, s75, s57
    s_mul_i32 s87, s4, 7296
    s_add_u32 s87, s87, s56
    s_add_u32 s4, s48, 3
    s_and_b32 s4, s4, 3
    s_mul_i32 s76, s4, 7296
    s_add_u32 s76, s76, s57
    s_mul_i32 s88, s4, 7296
    s_add_u32 s88, s88, s56
    s_lshl_b32 s4, s8, 11
    v_add_u32 v7, s4, v7
    s_add_u32 s4, s53, 65536
    v_add_u32 v6, s4, v9
    s_waitcnt vmcnt(0)
    buffer_store_dword v11, v10, s[28:31], s93 offen sc1
lw4:
    ds_read_b32 v8, v16 offset:80
    s_waitcnt lgkmcnt(0)
    v_cmp_ne_u32 vcc, 1, v8
    s_nop 1
    s_cbranch_vccnz lw4
    ds_read_b128 v[64:67], v7 offset:0
    ds_read_b128 v[68:71], v7 offset:1024
    s_mov_b32 s6, 0
    s_load_dword s64, s[28:29], s86 offset:0 glc
    s_load_dword s65, s[28:29], s87 offset:0 glc
    s_load_dword s66, s[28:29], s88 offset:0 glc
    s_branch chk5
rty5:
    s_add_u32 s6, s6, 1
    s_cmp_ge_u32 s6, 500000
    s_cbranch_scc1 back5
    s_sleep 2
    s_load_dword s64, s[28:29], s86 offset:0 glc
    s_load_dword s65, s[28:29], s87 offset:0 glc
    s_load_dword s66, s[28:29], s88 offset:0 glc
chk5:
    s_waitcnt lgkmcnt(0)
    s_xor_b32 s64, s64, s7
    s_xor_b32 s65, s65, s7
    s_or_b32 s64, s64, s65
    s_xor_b32 s66, s66, s7
    s_or_b32 s64, s64, s66
    s_cbranch_scc1 rty5
back5:
    buffer_load_dwordx4 v[28:31], v9, s[28:31], s74 offen offset:0 sc1
    buffer_load_dwordx4 v[32:35], v9, s[28:31], s74 offen offset:1024 sc1
    buffer_load_dwordx4 v[40:43], v9, s[28:31], s75 offen offset:0 sc1
    buffer_load_dwordx4 v[44:47], v9, s[28:31], s75 offen offset:1024 sc1
    buffer_load_dwordx4 v[52:55], v9, s[28:31], s76 offen offset:0 sc1
    buffer_load_dwordx4 v[56:59], v9, s[28:31], s76 offen offset:1024 sc1
    v_lshlrev_b32 v128, 16, v64
    v_and_b32 v129, 0xffff0000, v64
    v_lshlrev_b32 v130, 16, v65
    v_and_b32 v131, 0xffff0000, v65
    v_lshlrev_b32 v132, 16, v66
    v_and_b32 v133, 0xffff0000, v66
    v_lshlrev_b32 v134, 16, v67
    v_and_b32 v135, 0xffff0000, v67
    v_lshlrev_b32 v136, 16, v68
    v_and_b32 v137, 0xffff0000, v68
    v_lshlrev_b32 v138, 16, v69
    v_and_b32 v139, 0xffff0000, v69
    v_lshlrev_b32 v140, 16, v70
    v_and_b32 v141, 0xffff0000, v70
    v_lshlrev_b32 v142, 16, v71
    v_and_b32 v143, 0xffff0000, v71
    v_mov_b32 v144, 0x3f80
    v_mov_b32 v145, 0x3f800000
    s_mul_i32 s4, s52, 896
    s_mul_i32 s3, s49, 224
    s_add_u32 s4, s4, s3
    s_mul_i32 s3, s8, 64
    s_add_u32 s4, s4, s3
    s_add_u32 s5, s4, 917504
    v_mul_u32_u24 v5, 57344, v4
    v_add_u32 v5, v5, v18
    v_add_u32 v6, s53, v9
    s_lshl_b32 s56, s8, 9
    v_lshl_add_u32 v7, v2, 3, s56
lw6:
    ds_read_b32 v8, v19 offset:192
    s_waitcnt lgkmcnt(0)
    v_cmp_ne_u32 vcc, 1, v8
    s_nop 1
    s_cbranch_vccnz lw6
    ds_read_b64 v[100:101], v7 offset:30720
    s_waitcnt lgkmcnt(0)
    v_sub_f32 v102, 1.0, v100
    v_mul_f32 v100, 0x36124925, v100
    v_sub_f32 v103, 1.0, v101
    v_mul_f32 v101, 0x36124925, v101
    s_waitcnt vmcnt(4)
    v_dot2_f32_bf16 v128, v28, v144, v128
    v_dot2_f32_bf16 v129, v28, v145, v129
    v_dot2_f32_bf16 v130, v29, v144, v130
    v_dot2_f32_bf16 v131, v29, v145, v131
    v_dot2_f32_bf16 v132, v30, v144, v132
    v_dot2_f32_bf16 v133, v30, v145, v133
    v_dot2_f32_bf16 v134, v31, v144, v134
    v_dot2_f32_bf16 v135, v31, v145, v135
    v_dot2_f32_bf16 v136, v32, v144, v136
    v_dot2_f32_bf16 v137, v32, v145, v137
    v_dot2_f32_bf16 v138, v33, v144, v138
    v_dot2_f32_bf16 v139, v33, v145, v139
    v_dot2_f32_bf16 v140, v34, v144, v140
    v_dot2_f32_bf16 v141, v34, v145, v141
    v_dot2_f32_bf16 v142, v35, v144, v142
    v_dot2_f32_bf16 v143, v35, v145, v143
    s_waitcnt vmcnt(2)
    v_dot2_f32_bf16 v128, v40, v144, v128
    v_dot2_f32_bf16 v129, v40, v145, v129
    v_dot2_f32_bf16 v130, v41, v144, v130
    v_dot2_f32_bf16 v131, v41, v145, v131
    v_dot2_f32_bf16 v132, v42, v144, v132
    v_dot2_f32_bf16 v133, v42, v145, v133
    v_dot2_f32_bf16 v134, v43, v144, v134
    v_dot2_f32_bf16 v135, v43, v145, v135
    v_dot2_f32_bf16 v136, v44, v144, v136
    v_dot2_f32_bf16 v137, v44, v145, v137
    v_dot2_f32_bf16 v138, v45, v144, v138
    v_dot2_f32_bf16 v139, v45, v145, v139
    v_dot2_f32_bf16 v140, v46, v144, v140
    v_dot2_f32_bf16 v141, v46, v145, v141
    v_dot2_f32_bf16 v142, v47, v144, v142
    v_dot2_f32_bf16 v143, v47, v145, v143
    s_waitcnt vmcnt(0)
    v_dot2_f32_bf16 v128, v52, v144, v128
    v_dot2_f32_bf16 v129, v52, v145, v129
    v_dot2_f32_bf16 v130, v53, v144, v130
    v_dot2_f32_bf16 v131, v53, v145, v131
    v_dot2_f32_bf16 v132, v54, v144, v132
    v_dot2_f32_bf16 v133, v54, v145, v133
    v_dot2_f32_bf16 v134, v55, v144, v134
    v_dot2_f32_bf16 v135, v55, v145, v135
    v_dot2_f32_bf16 v136, v56, v144, v136
    v_dot2_f32_bf16 v137, v56, v145, v137
    v_dot2_f32_bf16 v138, v57, v144, v138
    v_dot2_f32_bf16 v139, v57, v145, v139
    v_dot2_f32_bf16 v140, v58, v144, v140
    v_dot2_f32_bf16 v141, v58, v145, v141
    v_dot2_f32_bf16 v142, v59, v144, v142
    v_dot2_f32_bf16 v143, v59, v145, v143
    s_nop 2
    ds_read_b32 v8, v19 offset:176
    v_mul_f32 v128, v102, v128
    v_mul_f32 v129, v102, v129
    v_mul_f32 v130, v102, v130
    v_mul_f32 v131, v102, v131
    v_mul_f32 v132, v103, v132
    v_mul_f32 v133, v103, v133
    v_mul_f32 v134, v103, v134
    v_mul_f32 v135, v103, v135
    v_mul_f32 v136, v102, v136
    v_mul_f32 v137, v102, v137
    v_mul_f32 v138, v102, v138
    v_mul_f32 v139, v102, v139
    v_mul_f32 v140, v103, v140
    v_mul_f32 v141, v103, v141
    v_mul_f32 v142, v103, v142
    v_mul_f32 v143, v103, v143
    s_waitcnt lgkmcnt(0)
    v_cmp_ne_u32 vcc, 1, v8
    s_nop 1
    s_cbranch_vccz L_sok
lw7:
    ds_read_b32 v8, v19 offset:176
    s_waitcnt lgkmcnt(0)
    v_cmp_ne_u32 vcc, 1, v8
    s_nop 1
    s_cbranch_vccnz lw7
L_sok:
    ds_read_b128 v[84:87], v6 offset:32768
    ds_read_b128 v[88:91], v6 offset:33792
    ds_read_b128 v[92:95], v6 offset:34816
    ds_read_b128 v[96:99], v6 offset:35840
    s_waitcnt lgkmcnt(3)
    v_fma_f32 v128, v84, v100, v128
    v_fma_f32 v129, v85, v100, v129
    v_fma_f32 v130, v86, v100, v130
    v_fma_f32 v131, v87, v100, v131
    v_cvt_pk_bf16_f32 v128, v128, v129
    v_cvt_pk_bf16_f32 v129, v130, v131
    buffer_store_dwordx2 v[128:129], v5, s[40:43], s4 offen offset:0
    s_waitcnt lgkmcnt(2)
    v_fma_f32 v132, v88, v101, v132
    v_fma_f32 v133, v89, v101, v133
    v_fma_f32 v134, v90, v101, v134
    v_fma_f32 v135, v91, v101, v135
    v_cvt_pk_bf16_f32 v132, v132, v133
    v_cvt_pk_bf16_f32 v133, v134, v135
    buffer_store_dwordx2 v[132:133], v5, s[40:43], s5 offen offset:0
    s_cmp_eq_u32 s8, 3
    s_cbranch_scc1 L_mfin
    s_waitcnt lgkmcnt(1)
    v_fma_f32 v136, v92, v100, v136
    v_fma_f32 v137, v93, v100, v137
    v_fma_f32 v138, v94, v100, v138
    v_fma_f32 v139, v95, v100, v139
    v_cvt_pk_bf16_f32 v136, v136, v137
    v_cvt_pk_bf16_f32 v137, v138, v139
    buffer_store_dwordx2 v[136:137], v5, s[40:43], s4 offen offset:32
    s_waitcnt lgkmcnt(0)
    v_fma_f32 v140, v96, v101, v140
    v_fma_f32 v141, v97, v101, v141
    v_fma_f32 v142, v98, v101, v142
    v_fma_f32 v143, v99, v101, v143
    v_cvt_pk_bf16_f32 v140, v140, v141
    v_cvt_pk_bf16_f32 v141, v142, v143
    buffer_store_dwordx2 v[140:141], v5, s[40:43], s5 offen offset:32
L_mfin:
    s_endpgm
L_gw:
    v_lshlrev_b32 v5, 4, v3
    s_mov_b32 s38, 896
    s_mov_b32 s39, 0x20000
    s_lshl_b32 s5, s51, 1
    s_add_u32 s5, s5, s8
    s_lshl_b32 s6, s8, 11
    s_add_u32 s4, s5, 0
    s_sub_u32 s3, s4, 14
    s_min_u32 s4, s4, s3
    s_lshl_b32 s4, s4, 6
    s_add_u32 m0, s6, 122880
    s_nop 0
    buffer_load_dwordx4 v5, s[36:39], s4 offen lds
    s_add_u32 s4, s5, 4
    s_sub_u32 s3, s4, 14
    s_min_u32 s4, s4, s3
    s_lshl_b32 s4, s4, 6
    s_add_u32 m0, s6, 131072
    s_nop 0
    buffer_load_dwordx4 v5, s[36:39], s4 offen lds
    s_add_u32 s4, s5, 8
    s_sub_u32 s3, s4, 14
    s_min_u32 s4, s4, s3
    s_lshl_b32 s4, s4, 6
    s_add_u32 m0, s6, 139264
    s_nop 0
    buffer_load_dwordx4 v5, s[36:39], s4 offen lds
    s_add_u32 s4, s5, 12
    s_sub_u32 s3, s4, 14
    s_min_u32 s4, s4, s3
    s_lshl_b32 s4, s4, 6
    s_add_u32 m0, s6, 147456
    s_nop 0
    buffer_load_dwordx4 v5, s[36:39], s4 offen lds
    s_branch L_nogw
L_S:
    s_load_dwordx2 s[32:33], s[0:1], 8
    s_load_dwordx2 s[36:37], s[0:1], 16
    v_lshlrev_b32 v9, 4, v2
    v_mov_b32 v10, 0
    v_mov_b32 v17, 1
    v_lshlrev_b32 v18, 3, v3
    s_add_u32 s52, s52, s48
    s_mov_b32 s54, 0x3b124925
    s_mov_b32 s55, 0xc3e00000
    v_lshrrev_b32 v8, 1, v4
    v_xor_b32 v8, v8, v3
    v_lshlrev_b32 v8, 4, v8
    v_lshl_add_u32 v8, v4, 7, v8
    v_add_u32 v12, s53, v8
    v_xor_b32 v13, 64, v12
    v_and_b32 v16, 3, v2
    v_lshlrev_b32 v16, 2, v16
    v_add_u32 v16, 162816, v16
    s_lshl_b32 s56, s8, 2
    s_add_u32 s56, s56, 162816
    v_mov_b32 v19, s56
    v_add_u32 v25, 122880, v9
    v_lshlrev_b32 v5, 2, v2
    v_add_u32 v5, 162816, v5
    ds_write_b32 v5, v10
    s_cmp_eq_u32 s45, 15
    s_cbranch_scc1 L_nofgS
    v_lshl_add_u32 v66, s45, 4, v4
    v_mov_b32 v64, 1.0
    v_cmp_eq_u32 vcc, 0, v66
    s_nop 1
    v_cndmask_b32 v64, v64, 0.5, vcc
    v_cmp_eq_u32 vcc, 224, v66
    s_nop 1
    v_cndmask_b32 v64, v64, 0.5, vcc
    v_cmp_lt_u32 vcc, 224, v66
    s_nop 1
    v_cndmask_b32 v64, v64, 0, vcc
    v_cvt_f32_u32 v66, v66
    v_mul_f32 v67, s54, v66
    s_lshl_b32 s4, s8, 11
    s_add_u32 s4, s4, 122880
    v_add_u32 v69, s4, v9
    s_add_u32 s4, s83, 8
    s_sub_u32 s5, s4, 14
    s_min_u32 s4, s4, s5
    v_lshl_add_u32 v68, s4, 5, v18
    v_cvt_f32_u32 v68, v68
    v_mul_f32 v8, v66, v68
    v_mul_f32 v48, s54, v8
    v_floor_f32 v48, v48
    v_fma_f32 v8, v48, s55, v8
    v_mul_f32 v48, s54, v8
    v_add_f32 v49, v48, v67
    v_add_f32 v50, v49, v67
    v_add_f32 v51, v50, v67
    v_add_f32 v52, v51, v67
    v_add_f32 v53, v52, v67
    v_add_f32 v54, v53, v67
    v_add_f32 v55, v54, v67
    v_cos_f32 v32, v48
    v_sin_f32 v40, v48
    v_cos_f32 v33, v49
    v_sin_f32 v41, v49
    v_cos_f32 v34, v50
    v_sin_f32 v42, v50
    v_cos_f32 v35, v51
    v_sin_f32 v43, v51
    v_cos_f32 v36, v52
    v_sin_f32 v44, v52
    v_cos_f32 v37, v53
    v_sin_f32 v45, v53
    v_cos_f32 v38, v54
    v_sin_f32 v46, v54
    v_cos_f32 v39, v55
    v_sin_f32 v47, v55
    v_pk_mul_f32 v[32:33], v[32:33], v[64:65] op_sel_hi:[1,0]
    v_pk_mul_f32 v[40:41], v[40:41], v[64:65] op_sel_hi:[1,0]
    v_pk_mul_f32 v[34:35], v[34:35], v[64:65] op_sel_hi:[1,0]
    v_pk_mul_f32 v[42:43], v[42:43], v[64:65] op_sel_hi:[1,0]
    v_pk_mul_f32 v[36:37], v[36:37], v[64:65] op_sel_hi:[1,0]
    v_pk_mul_f32 v[44:45], v[44:45], v[64:65] op_sel_hi:[1,0]
    v_pk_mul_f32 v[38:39], v[38:39], v[64:65] op_sel_hi:[1,0]
    v_pk_mul_f32 v[46:47], v[46:47], v[64:65] op_sel_hi:[1,0]
    v_cvt_pk_bf16_f32 v56, v32, v33
    v_cvt_pk_bf16_f32 v60, -v40, -v41
    v_cvt_pk_bf16_f32 v57, v34, v35
    v_cvt_pk_bf16_f32 v61, -v42, -v43
    v_cvt_pk_bf16_f32 v58, v36, v37
    v_cvt_pk_bf16_f32 v62, -v44, -v45
    v_cvt_pk_bf16_f32 v59, v38, v39
    v_cvt_pk_bf16_f32 v63, -v46, -v47
    ds_write_b128 v69, v[56:59] offset:16384
    ds_write_b128 v69, v[60:63] offset:17408
    s_add_u32 s4, s83, 12
    s_sub_u32 s5, s4, 14
    s_min_u32 s4, s4, s5
    v_lshl_add_u32 v68, s4, 5, v18
    v_cvt_f32_u32 v68, v68
    v_mul_f32 v8, v66, v68
    v_mul_f32 v48, s54, v8
    v_floor_f32 v48, v48
    v_fma_f32 v8, v48, s55, v8
    v_mul_f32 v48, s54, v8
    v_add_f32 v49, v48, v67
    v_add_f32 v50, v49, v67
    v_add_f32 v51, v50, v67
    v_add_f32 v52, v51, v67
    v_add_f32 v53, v52, v67
    v_add_f32 v54, v53, v67
    v_add_f32 v55, v54, v67
    v_cos_f32 v32, v48
    v_sin_f32 v40, v48
    v_cos_f32 v33, v49
    v_sin_f32 v41, v49
    v_cos_f32 v34, v50
    v_sin_f32 v42, v50
    v_cos_f32 v35, v51
    v_sin_f32 v43, v51
    v_cos_f32 v36, v52
    v_sin_f32 v44, v52
    v_cos_f32 v37, v53
    v_sin_f32 v45, v53
    v_cos_f32 v38, v54
    v_sin_f32 v46, v54
    v_cos_f32 v39, v55
    v_sin_f32 v47, v55
    v_pk_mul_f32 v[32:33], v[32:33], v[64:65] op_sel_hi:[1,0]
    v_pk_mul_f32 v[40:41], v[40:41], v[64:65] op_sel_hi:[1,0]
    v_pk_mul_f32 v[34:35], v[34:35], v[64:65] op_sel_hi:[1,0]
    v_pk_mul_f32 v[42:43], v[42:43], v[64:65] op_sel_hi:[1,0]
    v_pk_mul_f32 v[36:37], v[36:37], v[64:65] op_sel_hi:[1,0]
    v_pk_mul_f32 v[44:45], v[44:45], v[64:65] op_sel_hi:[1,0]
    v_pk_mul_f32 v[38:39], v[38:39], v[64:65] op_sel_hi:[1,0]
    v_pk_mul_f32 v[46:47], v[46:47], v[64:65] op_sel_hi:[1,0]
    v_cvt_pk_bf16_f32 v56, v32, v33
    v_cvt_pk_bf16_f32 v60, -v40, -v41
    v_cvt_pk_bf16_f32 v57, v34, v35
    v_cvt_pk_bf16_f32 v61, -v42, -v43
    v_cvt_pk_bf16_f32 v58, v36, v37
    v_cvt_pk_bf16_f32 v62, -v44, -v45
    v_cvt_pk_bf16_f32 v59, v38, v39
    v_cvt_pk_bf16_f32 v63, -v46, -v47
    ds_write_b128 v69, v[56:59] offset:24576
    ds_write_b128 v69, v[60:63] offset:25600
L_nofgS:
    s_mul_i32 s68, s46, 896
    s_mul_i32 s69, s45, 224
    s_mul_i32 s3, s8, 28672
    s_add_u32 s69, s69, s3
    s_mul_i32 s72, s8, 896
    s_lshl_b32 s4, s47, 1
    v_lshrrev_b32 v5, 3, v2
    v_mul_u32_u24 v5, 57344, v5
    v_and_b32 v6, 7, v2
    v_xor_b32 v6, v6, v3
    v_lshl_add_u32 v20, v6, 4, v5
    v_xor_b32 v21, 64, v20
    v_add_u32 v21, 458752, v21
    v_mul_u32_u24 v5, 4682, v2
    v_lshrrev_b32 v5, 16, v5
    v_mul_u32_u24 v6, 14, v5
    v_sub_u32 v6, v2, v6
    v_mul_u32_u24 v7, 896, v5
    v_lshl_add_u32 v23, v6, 4, v7
    v_add_u32 v6, s4, v6
    v_subrev_u32 v7, 14, v6
    v_min_u32 v6, v6, v7
    v_mul_u32_u24 v7, 3584, v5
    v_lshl_add_u32 v22, v6, 4, v7
    s_mov_b32 s18, 0x1c0000
    s_mov_b32 s19, 0x20000
    s_mov_b32 s22, 0x188000
    s_mov_b32 s23, 0x20000
    s_mov_b32 s26, 0x188000
    s_mov_b32 s27, 0x20000
    s_mov_b32 s34, 0xe1000
    s_mov_b32 s35, 0x20000
    s_mov_b32 s38, 0xe1000
    s_mov_b32 s39, 0x20000
    s_add_u32 s51, s51, 2
    s_sub_u32 s3, s51, 7
    s_min_u32 s51, s51, s3
    s_waitcnt lgkmcnt(0)
    s_add_u32 s12, s28, 0x1910000
    s_addc_u32 s13, s29, 0
    s_load_dword s14, s[12:13], 0
    s_load_dword s6, s[32:33], 0
    s_load_dword s6, s[36:37], 0
    s_lshr_b32 s86, s8, 1
    s_and_b32 s84, s9, 15
    s_lshr_b32 s87, s9, 4
    s_lshl_b32 s56, s50, 1
    s_add_u32 s87, s87, s56
    s_and_b32 s85, s8, 1
    s_lshl_b32 s56, s87, 1
    s_add_u32 s85, s85, s56
    s_and_b32 s82, s45, 3
    s_mul_i32 s73, s48, 401408
    s_mul_i32 s3, s8, 3584
    s_add_u32 s73, s73, s3
    s_mul_i32 s3, s49, 224
    s_add_u32 s73, s73, s3
    s_xor_b32 s3, s82, 0
    s_mul_i32 s3, s3, 7
    s_add_u32 s3, s3, 1
    s_lshr_b32 s3, s3, 1
    s_mul_i32 s3, s3, 28672
    s_add_u32 s74, s3, s73
    s_xor_b32 s3, s82, 1
    s_mul_i32 s3, s3, 7
    s_add_u32 s3, s3, 1
    s_lshr_b32 s3, s3, 1
    s_mul_i32 s3, s3, 28672
    s_add_u32 s75, s3, s73
    s_xor_b32 s3, s82, 2
    s_mul_i32 s3, s3, 7
    s_add_u32 s3, s3, 1
    s_lshr_b32 s3, s3, 1
    s_mul_i32 s3, s3, 28672
    s_add_u32 s76, s3, s73
    s_xor_b32 s3, s82, 3
    s_mul_i32 s3, s3, 7
    s_add_u32 s3, s3, 1
    s_lshr_b32 s3, s3, 1
    s_mul_i32 s3, s3, 28672
    s_add_u32 s77, s3, s73
    s_lshr_b32 s3, s82, 1
    s_xor_b32 s3, s3, 0
    s_mul_i32 s3, s3, 200704
    s_add_u32 s3, s3, s73
    s_add_u32 s3, s3, 86016
    s_mul_i32 s4, s47, 14336
    s_add_u32 s78, s3, s4
    s_sub_u32 s3, s3, s4
    s_add_u32 s79, s3, 14336
    s_lshr_b32 s3, s82, 1
    s_xor_b32 s3, s3, 1
    s_mul_i32 s3, s3, 200704
    s_add_u32 s3, s3, s73
    s_add_u32 s3, s3, 86016
    s_mul_i32 s4, s47, 14336
    s_add_u32 s80, s3, s4
    s_sub_u32 s3, s3, s4
    s_add_u32 s81, s3, 14336
    s_mul_i32 s95, s85, 450
    s_mul_i32 s57, s84, 32
    s_add_u32 s95, s95, s57
    s_mul_i32 s57, s86, 460800
    s_add_u32 s95, s95, s57
    s_mul_i32 s88, s44, 147712
    s_mul_i32 s57, s45, 8960
    s_add_u32 s88, s88, s57
    s_mul_i32 s57, s8, 1024
    s_add_u32 s88, s88, s57
    s_add_u32 s88, s88, 0x1400000
    s_mul_i32 s56, s46, 128
    s_add_u32 s56, s56, 0x1800000
    s_add_u32 s91, s88, 8192
    s_cmp_eq_u32 s45, 15
    s_cselect_b32 s88, s56, s88
    s_cselect_b32 s56, 64, 4096
    s_cselect_b64 vcc, -1, 0
    s_add_u32 s89, s88, s56
    v_lshlrev_b32 v30, 4, v3
    v_cndmask_b32 v30, v9, v30, vcc
    s_mul_i32 s90, s8, 38912
    s_mul_i32 s57, s84, 160000
    s_add_u32 s90, s90, s57
    s_add_u32 s90, s90, 0x1920800
    s_mul_i32 s93, s46, 2432
    s_mul_i32 s57, s45, 160000
    s_add_u32 s93, s93, s57
    s_add_u32 s93, s93, 0x1920800
    s_mul_i32 s94, s44, 147712
    s_mul_i32 s57, s45, 8960
    s_add_u32 s94, s94, s57
    s_mul_i32 s57, s8, 128
    s_add_u32 s94, s94, s57
    s_add_u32 s94, s94, 0x1402000
    s_min_u32 s56, s84, 14
    s_mul_i32 s96, s56, 8960
    s_mul_i32 s57, s85, 256
    s_add_u32 s96, s96, s57
    s_add_u32 s96, s96, 0x1400000
    s_lshr_b32 s56, s85, 4
    s_mul_i32 s92, s56, -4088
    s_add_u32 s92, s92, s96
    s_add_u32 s92, s92, 0x2000
    s_mul_i32 s97, s84, 160000
    s_mul_i32 s57, s8, 38912
    s_add_u32 s97, s97, s57
    s_mul_i32 s57, s87, 128
    s_add_u32 s97, s97, s57
    s_add_u32 s97, s97, 0x1920000
    s_mul_i32 s98, s8, 640000
    s_mul_i32 s57, s52, 2432
    s_add_u32 s98, s98, s57
    s_add_u32 s98, s98, 0x1920000
    s_mul_i32 s99, s52, 128
    s_add_u32 s99, s99, 0x1800000
    s_mul_i32 s100, s52, 116736
    s_mul_i32 s57, s49, 29184
    s_add_u32 s100, s100, s57
    s_mul_i32 s57, s8, 2048
    s_add_u32 s100, s100, s57
    s_add_u32 s100, s100, 0x800000
    s_mul_i32 s101, s52, 896
    s_mul_i32 s57, s49, 224
    s_add_u32 s101, s101, s57
    s_mul_i32 s57, s8, 64
    s_add_u32 s101, s101, s57
    v_mul_u32_u24 v8, 57600, v3
    v_lshl_add_u32 v8, v4, 1, v8
    v_mov_b32 v96, 0
    v_mov_b32 v104, 0
    v_mov_b32 v97, 0
    v_mov_b32 v105, 0
    v_mov_b32 v98, 0
    v_mov_b32 v106, 0
    v_mov_b32 v99, 0
    v_mov_b32 v107, 0
    v_mov_b32 v100, 0
    v_mov_b32 v108, 0
    v_mov_b32 v101, 0
    v_mov_b32 v109, 0
    v_mov_b32 v102, 0
    v_mov_b32 v110, 0
    v_mov_b32 v103, 0
    v_mov_b32 v111, 0
    v_cvt_f32_u32 v160, v4
    v_mul_f32 v160, 0x3a000000, v160
    v_add_f32 v161, 0x3c000000, v160
    v_lshl_add_u32 v162, v3, 8, s46
    v_cvt_f32_u32 v162, v162
    v_add_f32 v163, 0x00000000, v162
    v_mul_f32 v164, v160, v163
    v_mul_f32 v165, v161, v163
    v_cos_f32 v166, v164
    v_sin_f32 v168, v164
    v_cos_f32 v167, v165
    v_sin_f32 v169, v165
    v_cvt_pk_bf16_f32 v128, v166, v168
    v_cvt_pk_bf16_f32 v144, -v168, v166
    v_cvt_pk_bf16_f32 v136, v167, v169
    v_cvt_pk_bf16_f32 v152, -v169, v167
    v_add_f32 v163, 0x42800000, v162
    v_mul_f32 v164, v160, v163
    v_mul_f32 v165, v161, v163
    v_cos_f32 v166, v164
    v_sin_f32 v168, v164
    v_cos_f32 v167, v165
    v_sin_f32 v169, v165
    v_cvt_pk_bf16_f32 v129, v166, v168
    v_cvt_pk_bf16_f32 v145, -v168, v166
    v_cvt_pk_bf16_f32 v137, v167, v169
    v_cvt_pk_bf16_f32 v153, -v169, v167
    v_add_f32 v163, 0x43000000, v162
    v_mul_f32 v164, v160, v163
    v_mul_f32 v165, v161, v163
    v_cos_f32 v166, v164
    v_sin_f32 v168, v164
    v_cos_f32 v167, v165
    v_sin_f32 v169, v165
    v_cvt_pk_bf16_f32 v130, v166, v168
    v_cvt_pk_bf16_f32 v146, -v168, v166
    v_cvt_pk_bf16_f32 v138, v167, v169
    v_cvt_pk_bf16_f32 v154, -v169, v167
    v_add_f32 v163, 0x43400000, v162
    v_mul_f32 v164, v160, v163
    v_mul_f32 v165, v161, v163
    v_cos_f32 v166, v164
    v_sin_f32 v168, v164
    v_cos_f32 v167, v165
    v_sin_f32 v169, v165
    v_cvt_pk_bf16_f32 v131, v166, v168
    v_cvt_pk_bf16_f32 v147, -v168, v166
    v_cvt_pk_bf16_f32 v139, v167, v169
    v_cvt_pk_bf16_f32 v155, -v169, v167
    v_add_f32 v163, 0x44800000, v162
    v_mul_f32 v164, v160, v163
    v_mul_f32 v165, v161, v163
    v_cos_f32 v166, v164
    v_sin_f32 v168, v164
    v_cos_f32 v167, v165
    v_sin_f32 v169, v165
    v_cvt_pk_bf16_f32 v132, v166, v168
    v_cvt_pk_bf16_f32 v148, -v168, v166
    v_cvt_pk_bf16_f32 v140, v167, v169
    v_cvt_pk_bf16_f32 v156, -v169, v167
    v_add_f32 v163, 0x44880000, v162
    v_mul_f32 v164, v160, v163
    v_mul_f32 v165, v161, v163
    v_cos_f32 v166, v164
    v_sin_f32 v168, v164
    v_cos_f32 v167, v165
    v_sin_f32 v169, v165
    v_cvt_pk_bf16_f32 v133, v166, v168
    v_cvt_pk_bf16_f32 v149, -v168, v166
    v_cvt_pk_bf16_f32 v141, v167, v169
    v_cvt_pk_bf16_f32 v157, -v169, v167
    v_add_f32 v163, 0x44900000, v162
    v_mul_f32 v164, v160, v163
    v_mul_f32 v165, v161, v163
    v_cos_f32 v166, v164
    v_sin_f32 v168, v164
    v_cos_f32 v167, v165
    v_sin_f32 v169, v165
    v_cvt_pk_bf16_f32 v134, v166, v168
    v_cvt_pk_bf16_f32 v150, -v168, v166
    v_cvt_pk_bf16_f32 v142, v167, v169
    v_cvt_pk_bf16_f32 v158, -v169, v167
    v_add_f32 v163, 0x44980000, v162
    v_mul_f32 v164, v160, v163
    v_mul_f32 v165, v161, v163
    v_cos_f32 v166, v164
    v_sin_f32 v168, v164
    v_cos_f32 v167, v165
    v_sin_f32 v169, v165
    v_cvt_pk_bf16_f32 v135, v166, v168
    v_cvt_pk_bf16_f32 v151, -v168, v166
    v_cvt_pk_bf16_f32 v143, v167, v169
    v_cvt_pk_bf16_f32 v159, -v169, v167
    v_lshl_add_u32 v160, s86, 5, v4
    v_cvt_f32_u32 v160, v160
    v_mul_f32 v160, 0x3c800000, v160
    v_lshlrev_b32 v161, 2, v3
    v_cvt_f32_u32 v161, v161
    v_add_f32 v162, 0x00000000, v161
    v_mul_f32 v162, v162, v160
    v_cos_f32 v164, v162
    v_sin_f32 v165, v162
    v_add_f32 v163, 0x3f800000, v161
    v_mul_f32 v163, v163, v160
    v_cos_f32 v166, v163
    v_sin_f32 v167, v163
    v_cvt_pk_bf16_f32 v32, v164, v165
    v_cvt_pk_bf16_f32 v48, v164, v165
    v_cvt_pk_bf16_f32 v64, -v165, v164
    v_cvt_pk_bf16_f32 v80, -v165, v164
    v_add_f32 v162, 0x40000000, v161
    v_mul_f32 v162, v162, v160
    v_cos_f32 v164, v162
    v_sin_f32 v165, v162
    v_cvt_pk_bf16_f32 v33, v166, v167
    v_cvt_pk_bf16_f32 v49, -v167, v166
    v_cvt_pk_bf16_f32 v65, -v167, v166
    v_cvt_pk_bf16_f32 v81, -v166, -v167
    v_add_f32 v163, 0x40400000, v161
    v_mul_f32 v163, v163, v160
    v_cos_f32 v166, v163
    v_sin_f32 v167, v163
    v_cvt_pk_bf16_f32 v34, v164, v165
    v_cvt_pk_bf16_f32 v50, -v164, -v165
    v_cvt_pk_bf16_f32 v66, -v165, v164
    v_cvt_pk_bf16_f32 v82, v165, -v164
    v_add_f32 v162, 0x41800000, v161
    v_mul_f32 v162, v162, v160
    v_cos_f32 v164, v162
    v_sin_f32 v165, v162
    v_cvt_pk_bf16_f32 v35, v166, v167
    v_cvt_pk_bf16_f32 v51, v167, -v166
    v_cvt_pk_bf16_f32 v67, -v167, v166
    v_cvt_pk_bf16_f32 v83, v166, v167
    v_add_f32 v163, 0x41880000, v161
    v_mul_f32 v163, v163, v160
    v_cos_f32 v166, v163
    v_sin_f32 v167, v163
    v_cvt_pk_bf16_f32 v36, v164, v165
    v_cvt_pk_bf16_f32 v52, v164, v165
    v_cvt_pk_bf16_f32 v68, -v165, v164
    v_cvt_pk_bf16_f32 v84, -v165, v164
    v_add_f32 v162, 0x41900000, v161
    v_mul_f32 v162, v162, v160
    v_cos_f32 v164, v162
    v_sin_f32 v165, v162
    v_cvt_pk_bf16_f32 v37, v166, v167
    v_cvt_pk_bf16_f32 v53, -v167, v166
    v_cvt_pk_bf16_f32 v69, -v167, v166
    v_cvt_pk_bf16_f32 v85, -v166, -v167
    v_add_f32 v163, 0x41980000, v161
    v_mul_f32 v163, v163, v160
    v_cos_f32 v166, v163
    v_sin_f32 v167, v163
    v_cvt_pk_bf16_f32 v38, v164, v165
    v_cvt_pk_bf16_f32 v54, -v164, -v165
    v_cvt_pk_bf16_f32 v70, -v165, v164
    v_cvt_pk_bf16_f32 v86, v165, -v164
    v_add_f32 v162, 0x42000000, v161
    v_mul_f32 v162, v162, v160
    v_cos_f32 v164, v162
    v_sin_f32 v165, v162
    v_cvt_pk_bf16_f32 v39, v166, v167
    v_cvt_pk_bf16_f32 v55, v167, -v166
    v_cvt_pk_bf16_f32 v71, -v167, v166
    v_cvt_pk_bf16_f32 v87, v166, v167
    v_add_f32 v163, 0x42040000, v161
    v_mul_f32 v163, v163, v160
    v_cos_f32 v166, v163
    v_sin_f32 v167, v163
    v_cvt_pk_bf16_f32 v40, v164, v165
    v_cvt_pk_bf16_f32 v56, v164, v165
    v_cvt_pk_bf16_f32 v72, -v165, v164
    v_cvt_pk_bf16_f32 v88, -v165, v164
    v_add_f32 v162, 0x42080000, v161
    v_mul_f32 v162, v162, v160
    v_cos_f32 v164, v162
    v_sin_f32 v165, v162
    v_cvt_pk_bf16_f32 v41, v166, v167
    v_cvt_pk_bf16_f32 v57, -v167, v166
    v_cvt_pk_bf16_f32 v73, -v167, v166
    v_cvt_pk_bf16_f32 v89, -v166, -v167
    v_add_f32 v163, 0x420c0000, v161
    v_mul_f32 v163, v163, v160
    v_cos_f32 v166, v163
    v_sin_f32 v167, v163
    v_cvt_pk_bf16_f32 v42, v164, v165
    v_cvt_pk_bf16_f32 v58, -v164, -v165
    v_cvt_pk_bf16_f32 v74, -v165, v164
    v_cvt_pk_bf16_f32 v90, v165, -v164
    v_add_f32 v162, 0x42400000, v161
    v_mul_f32 v162, v162, v160
    v_cos_f32 v164, v162
    v_sin_f32 v165, v162
    v_cvt_pk_bf16_f32 v43, v166, v167
    v_cvt_pk_bf16_f32 v59, v167, -v166
    v_cvt_pk_bf16_f32 v75, -v167, v166
    v_cvt_pk_bf16_f32 v91, v166, v167
    v_add_f32 v163, 0x42440000, v161
    v_mul_f32 v163, v163, v160
    v_cos_f32 v166, v163
    v_sin_f32 v167, v163
    v_cvt_pk_bf16_f32 v44, v164, v165
    v_cvt_pk_bf16_f32 v60, v164, v165
    v_cvt_pk_bf16_f32 v76, -v165, v164
    v_cvt_pk_bf16_f32 v92, -v165, v164
    v_add_f32 v162, 0x42480000, v161
    v_mul_f32 v162, v162, v160
    v_cos_f32 v164, v162
    v_sin_f32 v165, v162
    v_cvt_pk_bf16_f32 v45, v166, v167
    v_cvt_pk_bf16_f32 v61, -v167, v166
    v_cvt_pk_bf16_f32 v77, -v167, v166
    v_cvt_pk_bf16_f32 v93, -v166, -v167
    v_add_f32 v163, 0x424c0000, v161
    v_mul_f32 v163, v163, v160
    v_cos_f32 v166, v163
    v_sin_f32 v167, v163
    v_cvt_pk_bf16_f32 v46, v164, v165
    v_cvt_pk_bf16_f32 v62, -v164, -v165
    v_cvt_pk_bf16_f32 v78, -v165, v164
    v_cvt_pk_bf16_f32 v94, v165, -v164
    v_cvt_pk_bf16_f32 v47, v166, v167
    v_cvt_pk_bf16_f32 v63, v167, -v166
    v_cvt_pk_bf16_f32 v79, -v167, v166
    v_cvt_pk_bf16_f32 v95, v166, v167
    s_lshl_b32 s56, s8, 2
    s_add_u32 s56, s56, 0
    v_lshl_add_u32 v5, v3, 10, s56
    v_lshl_add_u32 v5, v4, 4, v5
    s_lshl_b32 s56, s8, 10
    s_add_u32 s56, s56, 0
    v_add_u32 v6, s56, v9
    s_waitcnt lgkmcnt(0)
    s_setprio 1
    s_mul_i32 s7, s14, 0x9e3779b1
    s_add_u32 s7, s7, 0x7f4a7c15
    v_mov_b32 v11, s7
    s_barrier
    ds_read_b128 a[0:3], v12 offset:0
    ds_read_b128 a[4:7], v12 offset:2048
    ds_read_b128 a[16:19], v25 offset:0
    ds_read_b128 a[20:23], v25 offset:1024
    s_waitcnt lgkmcnt(0)
    v_mfma_f32_16x16x32_bf16 v[112:115], a[0:3], a[16:19], 0
    ds_read_b128 a[8:11], v13 offset:0
    v_mfma_f32_16x16x32_bf16 v[120:123], a[4:7], a[16:19], 0
    ds_read_b128 a[12:15], v13 offset:2048
    v_mfma_f32_16x16x32_bf16 v[116:119], a[0:3], a[20:23], 0
    ds_read_b128 a[24:27], v25 offset:2048
    v_mfma_f32_16x16x32_bf16 v[124:127], a[4:7], a[20:23], 0
    ds_read_b128 a[28:31], v25 offset:3072
    buffer_store_dword v11, v10, s[28:31], s93 offen sc1
    s_lshl_b32 s70, s51, 7
    s_add_u32 s70, s70, s68
    s_mul_i32 s71, s51, 229376
    s_add_u32 s71, s71, s69
    s_add_u32 m0, s53, 32768
    s_nop 0
    buffer_load_dwordx4 v20, s[16:19], s70 offen lds
    s_add_u32 m0, s53, 33792
    s_nop 0
    buffer_load_dwordx4 v21, s[16:19], s70 offen lds
    s_add_u32 m0, s72, 94208
    s_mov_b32 exec_hi, 0xffffff
    buffer_load_dwordx4 v22, s[20:23], s71 offen lds
    s_mov_b32 exec_hi, -1
    s_add_u32 s71, s71, 14336
    s_add_u32 m0, s72, 97792
    s_mov_b32 exec_hi, 0xffffff
    buffer_load_dwordx4 v22, s[20:23], s71 offen lds
    s_mov_b32 exec_hi, -1
    s_add_u32 s70, s70, 917504
    s_add_u32 m0, s53, 34816
    s_nop 0
    buffer_load_dwordx4 v20, s[16:19], s70 offen lds
    s_add_u32 m0, s53, 35840
    s_nop 0
    buffer_load_dwordx4 v21, s[16:19], s70 offen lds
    s_add_u32 s71, s71, 100352
    s_add_u32 m0, s72, 101376
    s_mov_b32 exec_hi, 0xffffff
    buffer_load_dwordx4 v22, s[20:23], s71 offen lds
    s_mov_b32 exec_hi, -1
    s_add_u32 s71, s71, 14336
    s_add_u32 m0, s72, 104960
    s_mov_b32 exec_hi, 0xffffff
    buffer_load_dwordx4 v22, s[20:23], s71 offen lds
    s_mov_b32 exec_hi, -1
    s_add_u32 s51, s51, 1
    s_cmp_eq_u32 s51, 7
    s_cselect_b32 s51, 0, s51
    s_barrier
    s_waitcnt lgkmcnt(0)
    v_mfma_f32_16x16x32_bf16 v[112:115], a[8:11], a[24:27], v[112:115]
    ds_read_b128 a[0:3], v12 offset:16384
    v_mfma_f32_16x16x32_bf16 v[120:123], a[12:15], a[24:27], v[120:123]
    ds_read_b128 a[4:7], v12 offset:18432
    v_mfma_f32_16x16x32_bf16 v[116:119], a[8:11], a[28:31], v[116:119]
    ds_read_b128 a[16:19], v25 offset:4096
    v_mfma_f32_16x16x32_bf16 v[124:127], a[12:15], a[28:31], v[124:127]
    ds_read_b128 a[20:23], v25 offset:5120
    s_lshl_b32 s70, s51, 7
    s_add_u32 s70, s70, s68
    s_mul_i32 s71, s51, 229376
    s_add_u32 s71, s71, s69
    s_add_u32 m0, s53, 49152
    s_nop 0
    buffer_load_dwordx4 v20, s[16:19], s70 offen lds
    s_add_u32 m0, s53, 50176
    s_nop 0
    buffer_load_dwordx4 v21, s[16:19], s70 offen lds
    s_add_u32 m0, s72, 108544
    s_mov_b32 exec_hi, 0xffffff
    buffer_load_dwordx4 v22, s[20:23], s71 offen lds
    s_mov_b32 exec_hi, -1
    s_add_u32 s71, s71, 14336
    s_add_u32 m0, s72, 112128
    s_mov_b32 exec_hi, 0xffffff
    buffer_load_dwordx4 v22, s[20:23], s71 offen lds
    s_mov_b32 exec_hi, -1
    s_waitcnt lgkmcnt(0)
    v_mfma_f32_16x16x32_bf16 v[112:115], a[0:3], a[16:19], v[112:115]
    ds_read_b128 a[8:11], v13 offset:16384
    v_mfma_f32_16x16x32_bf16 v[120:123], a[4:7], a[16:19], v[120:123]
    ds_read_b128 a[12:15], v13 offset:18432
    v_mfma_f32_16x16x32_bf16 v[116:119], a[0:3], a[20:23], v[116:119]
    ds_read_b128 a[24:27], v25 offset:6144
    v_mfma_f32_16x16x32_bf16 v[124:127], a[4:7], a[20:23], v[124:127]
    ds_read_b128 a[28:31], v25 offset:7168
    s_add_u32 s70, s70, 917504
    s_add_u32 m0, s53, 51200
    s_nop 0
    buffer_load_dwordx4 v20, s[16:19], s70 offen lds
    s_add_u32 m0, s53, 52224
    s_nop 0
    buffer_load_dwordx4 v21, s[16:19], s70 offen lds
    s_add_u32 s71, s71, 100352
    s_add_u32 m0, s72, 115712
    s_mov_b32 exec_hi, 0xffffff
    buffer_load_dwordx4 v22, s[20:23], s71 offen lds
    s_mov_b32 exec_hi, -1
    s_add_u32 s71, s71, 14336
    s_add_u32 m0, s72, 119296
    s_mov_b32 exec_hi, 0xffffff
    buffer_load_dwordx4 v22, s[20:23], s71 offen lds
    s_mov_b32 exec_hi, -1
    s_add_u32 s51, s51, 1
    s_cmp_eq_u32 s51, 7
    s_cselect_b32 s51, 0, s51
    s_waitcnt vmcnt(8)
    s_barrier
    s_waitcnt lgkmcnt(0)
    v_mfma_f32_16x16x32_bf16 v[112:115], a[8:11], a[24:27], v[112:115]
    ds_read_b128 a[0:3], v12 offset:32768
    v_mfma_f32_16x16x32_bf16 v[120:123], a[12:15], a[24:27], v[120:123]
    ds_read_b128 a[4:7], v12 offset:34816
    v_mfma_f32_16x16x32_bf16 v[116:119], a[8:11], a[28:31], v[116:119]
    ds_read_b128 a[16:19], v25 offset:8192
    v_mfma_f32_16x16x32_bf16 v[124:127], a[12:15], a[28:31], v[124:127]
    ds_read_b128 a[20:23], v25 offset:9216
    s_lshl_b32 s70, s51, 7
    s_add_u32 s70, s70, s68
    s_mul_i32 s71, s51, 229376
    s_add_u32 s71, s71, s69
    s_add_u32 m0, s53, 0
    s_nop 0
    buffer_load_dwordx4 v20, s[16:19], s70 offen lds
    s_add_u32 m0, s53, 1024
    s_nop 0
    buffer_load_dwordx4 v21, s[16:19], s70 offen lds
    s_add_u32 m0, s72, 65536
    s_mov_b32 exec_hi, 0xffffff
    buffer_load_dwordx4 v22, s[20:23], s71 offen lds
    s_mov_b32 exec_hi, -1
    s_add_u32 s71, s71, 14336
    s_add_u32 m0, s72, 69120
    s_mov_b32 exec_hi, 0xffffff
    buffer_load_dwordx4 v22, s[20:23], s71 offen lds
    s_mov_b32 exec_hi, -1
    s_waitcnt lgkmcnt(0)
    v_mfma_f32_16x16x32_bf16 v[112:115], a[0:3], a[16:19], v[112:115]
    ds_read_b128 a[8:11], v13 offset:32768
    v_mfma_f32_16x16x32_bf16 v[120:123], a[4:7], a[16:19], v[120:123]
    ds_read_b128 a[12:15], v13 offset:34816
    v_mfma_f32_16x16x32_bf16 v[116:119], a[0:3], a[20:23], v[116:119]
    ds_read_b128 a[24:27], v25 offset:10240
    v_mfma_f32_16x16x32_bf16 v[124:127], a[4:7], a[20:23], v[124:127]
    ds_read_b128 a[28:31], v25 offset:11264
    s_add_u32 s70, s70, 917504
    s_add_u32 m0, s53, 2048
    s_nop 0
    buffer_load_dwordx4 v20, s[16:19], s70 offen lds
    s_add_u32 m0, s53, 3072
    s_nop 0
    buffer_load_dwordx4 v21, s[16:19], s70 offen lds
    s_add_u32 s71, s71, 100352
    s_add_u32 m0, s72, 72704
    s_mov_b32 exec_hi, 0xffffff
    buffer_load_dwordx4 v22, s[20:23], s71 offen lds
    s_mov_b32 exec_hi, -1
    s_add_u32 s71, s71, 14336
    s_add_u32 m0, s72, 76288
    s_mov_b32 exec_hi, 0xffffff
    buffer_load_dwordx4 v22, s[20:23], s71 offen lds
    s_mov_b32 exec_hi, -1
    s_add_u32 s51, s51, 1
    s_cmp_eq_u32 s51, 7
    s_cselect_b32 s51, 0, s51
    s_waitcnt vmcnt(8)
    s_barrier
    s_waitcnt lgkmcnt(0)
    v_mfma_f32_16x16x32_bf16 v[112:115], a[8:11], a[24:27], v[112:115]
    ds_read_b128 a[0:3], v12 offset:49152
    v_mfma_f32_16x16x32_bf16 v[120:123], a[12:15], a[24:27], v[120:123]
    ds_read_b128 a[4:7], v12 offset:51200
    v_mfma_f32_16x16x32_bf16 v[116:119], a[8:11], a[28:31], v[116:119]
    ds_read_b128 a[16:19], v25 offset:12288
    v_mfma_f32_16x16x32_bf16 v[124:127], a[12:15], a[28:31], v[124:127]
    ds_read_b128 a[20:23], v25 offset:13312
    s_lshl_b32 s70, s51, 7
    s_add_u32 s70, s70, s68
    s_mul_i32 s71, s51, 229376
    s_add_u32 s71, s71, s69
    s_add_u32 m0, s53, 16384
    s_nop 0
    buffer_load_dwordx4 v20, s[16:19], s70 offen lds
    s_add_u32 m0, s53, 17408
    s_nop 0
    buffer_load_dwordx4 v21, s[16:19], s70 offen lds
    s_add_u32 m0, s72, 79872
    s_mov_b32 exec_hi, 0xffffff
    buffer_load_dwordx4 v22, s[20:23], s71 offen lds
    s_mov_b32 exec_hi, -1
    s_add_u32 s71, s71, 14336
    s_add_u32 m0, s72, 83456
    s_mov_b32 exec_hi, 0xffffff
    buffer_load_dwordx4 v22, s[20:23], s71 offen lds
    s_mov_b32 exec_hi, -1
    s_add_u32 s70, s70, 917504
    s_add_u32 m0, s53, 18432
    s_nop 0
    buffer_load_dwordx4 v20, s[16:19], s70 offen lds
    s_waitcnt lgkmcnt(0)
    v_mfma_f32_16x16x32_bf16 v[112:115], a[0:3], a[16:19], v[112:115]
    ds_read_b128 a[8:11], v13 offset:49152
    v_mfma_f32_16x16x32_bf16 v[120:123], a[4:7], a[16:19], v[120:123]
    ds_read_b128 a[12:15], v13 offset:51200
    v_mfma_f32_16x16x32_bf16 v[116:119], a[0:3], a[20:23], v[116:119]
    ds_read_b128 a[24:27], v25 offset:14336
    v_mfma_f32_16x16x32_bf16 v[124:127], a[4:7], a[20:23], v[124:127]
    ds_read_b128 a[28:31], v25 offset:15360
    s_add_u32 m0, s53, 19456
    s_nop 0
    buffer_load_dwordx4 v21, s[16:19], s70 offen lds
    s_add_u32 s71, s71, 100352
    s_add_u32 m0, s72, 87040
    s_mov_b32 exec_hi, 0xffffff
    buffer_load_dwordx4 v22, s[20:23], s71 offen lds
    s_mov_b32 exec_hi, -1
    s_add_u32 s71, s71, 14336
    s_add_u32 m0, s72, 90624
    s_mov_b32 exec_hi, 0xffffff
    buffer_load_dwordx4 v22, s[20:23], s71 offen lds
    s_mov_b32 exec_hi, -1
    s_add_u32 s51, s51, 1
    s_cmp_eq_u32 s51, 7
    s_cselect_b32 s51, 0, s51
    s_lshr_b32 s5, s9, 2
    s_lshl_b32 s5, s5, 1
    s_and_b32 s3, s9, 1
    s_add_u32 s5, s5, s3
    s_add_u32 s56, s9, 1
    s_and_b32 s56, s56, 2
    s_lshl_b32 s56, s56, 29
    s_mul_i32 s4, s5, 25088
    s_mul_i32 s3, s48, 401408
    s_add_u32 s4, s4, s3
    s_mul_i32 s3, s8, 6272
    s_add_u32 s4, s4, s3
    s_add_u32 s4, s4, s56
    v_min_u32 v7, 48, v2
    v_lshlrev_b32 v7, 7, v7
    buffer_load_dword v15, v7, s[24:27], s4 offen
    s_mul_i32 s4, s5, 57600
    s_mul_i32 s3, s8, 14400
    s_add_u32 s4, s4, s3
    s_mul_i32 s3, s50, 1800
    s_add_u32 s4, s4, s3
    s_add_u32 s4, s4, s56
    v_lshrrev_b32 v7, 2, v2
    v_lshlrev_b32 v7, 7, v7
    v_min_u32 v7, 1796, v7
    buffer_load_dword v15, v7, s[32:35], s4 offen
    buffer_load_dword v15, v7, s[36:39], s4 offen
    s_andn2_b32 s5, s45, 1
    v_bfe_u32 v26, v2, 3, 1
    s_mul_i32 s4, s46, 116736
    s_mul_i32 s3, s5, 7296
    s_add_u32 s4, s4, s3
    s_add_u32 s4, s4, s56
    s_add_u32 s4, s4, 0x1c00
    v_mul_u32_u24 v7, 7296, v26
    buffer_load_dword v15, v7, s[28:31], s4 offen sc1
    s_mul_i32 s4, s44, 147712
    s_mul_i32 s3, s5, 8960
    s_add_u32 s4, s4, s3
    s_mul_i32 s3, s8, 128
    s_add_u32 s4, s4, s3
    s_add_u32 s4, s4, s56
    s_add_u32 s4, s4, 0x1402000
    v_mul_u32_u24 v7, 8960, v26
    buffer_load_dword v15, v7, s[28:31], s4 offen sc1
    s_andn2_b32 s5, s49, 1
    s_mul_i32 s4, s46, 116736
    s_mul_i32 s3, s5, 29184
    s_add_u32 s4, s4, s3
    s_mul_i32 s3, s48, 7296
    s_add_u32 s4, s4, s3
    s_add_u32 s4, s4, s56
    s_add_u32 s4, s4, 0x801c00
    v_mul_u32_u24 v7, 29184, v26
    buffer_load_dword v15, v7, s[28:31], s4 offen sc1
    s_waitcnt vmcnt(14)
    s_barrier
    s_waitcnt lgkmcnt(0)
    v_mfma_f32_16x16x32_bf16 v[112:115], a[8:11], a[24:27], v[112:115]
    ds_read_b128 a[0:3], v12 offset:0
    v_mfma_f32_16x16x32_bf16 v[120:123], a[12:15], a[24:27], v[120:123]
    ds_read_b128 a[4:7], v12 offset:2048
    v_mfma_f32_16x16x32_bf16 v[116:119], a[8:11], a[28:31], v[116:119]
    ds_read_b128 a[16:19], v25 offset:16384
    v_mfma_f32_16x16x32_bf16 v[124:127], a[12:15], a[28:31], v[124:127]
    ds_read_b128 a[20:23], v25 offset:17408
    s_lshl_b32 s70, s51, 7
    s_add_u32 s70, s70, s68
    s_mul_i32 s71, s51, 229376
    s_add_u32 s71, s71, s69
    s_add_u32 m0, s53, 32768
    s_nop 0
    buffer_load_dwordx4 v20, s[16:19], s70 offen lds
    s_add_u32 m0, s53, 33792
    s_nop 0
    buffer_load_dwordx4 v21, s[16:19], s70 offen lds
    s_add_u32 m0, s72, 94208
    s_mov_b32 exec_hi, 0xffffff
    buffer_load_dwordx4 v22, s[20:23], s71 offen lds
    s_mov_b32 exec_hi, -1
    s_add_u32 s71, s71, 14336
    s_add_u32 m0, s72, 97792
    s_mov_b32 exec_hi, 0xffffff
    buffer_load_dwordx4 v22, s[20:23], s71 offen lds
    s_mov_b32 exec_hi, -1
    s_waitcnt lgkmcnt(0)
    v_mfma_f32_16x16x32_bf16 v[112:115], a[0:3], a[16:19], v[112:115]
    ds_read_b128 a[8:11], v13 offset:0
    v_mfma_f32_16x16x32_bf16 v[120:123], a[4:7], a[16:19], v[120:123]
    ds_read_b128 a[12:15], v13 offset:2048
    v_mfma_f32_16x16x32_bf16 v[116:119], a[0:3], a[20:23], v[116:119]
    ds_read_b128 a[24:27], v25 offset:18432
    v_mfma_f32_16x16x32_bf16 v[124:127], a[4:7], a[20:23], v[124:127]
    ds_read_b128 a[28:31], v25 offset:19456
    s_add_u32 s70, s70, 917504
    s_add_u32 m0, s53, 34816
    s_nop 0
    buffer_load_dwordx4 v20, s[16:19], s70 offen lds
    s_add_u32 m0, s53, 35840
    s_nop 0
    buffer_load_dwordx4 v21, s[16:19], s70 offen lds
    s_add_u32 s71, s71, 100352
    s_add_u32 m0, s72, 101376
    s_mov_b32 exec_hi, 0xffffff
    buffer_load_dwordx4 v22, s[20:23], s71 offen lds
    s_mov_b32 exec_hi, -1
    s_add_u32 s71, s71, 14336
    s_add_u32 m0, s72, 104960
    s_mov_b32 exec_hi, 0xffffff
    buffer_load_dwordx4 v22, s[20:23], s71 offen lds
    s_mov_b32 exec_hi, -1
    s_add_u32 s51, s51, 1
    s_cmp_eq_u32 s51, 7
    s_cselect_b32 s51, 0, s51
    s_waitcnt vmcnt(14)
    s_barrier
    s_waitcnt lgkmcnt(0)
    v_mfma_f32_16x16x32_bf16 v[112:115], a[8:11], a[24:27], v[112:115]
    ds_read_b128 a[0:3], v12 offset:16384
    v_mfma_f32_16x16x32_bf16 v[120:123], a[12:15], a[24:27], v[120:123]
    ds_read_b128 a[4:7], v12 offset:18432
    v_mfma_f32_16x16x32_bf16 v[116:119], a[8:11], a[28:31], v[116:119]
    ds_read_b128 a[16:19], v25 offset:20480
    v_mfma_f32_16x16x32_bf16 v[124:127], a[12:15], a[28:31], v[124:127]
    ds_read_b128 a[20:23], v25 offset:21504
    s_waitcnt lgkmcnt(0)
    v_mfma_f32_16x16x32_bf16 v[112:115], a[0:3], a[16:19], v[112:115]
    ds_read_b128 a[8:11], v13 offset:16384
    v_mfma_f32_16x16x32_bf16 v[120:123], a[4:7], a[16:19], v[120:123]
    ds_read_b128 a[12:15], v13 offset:18432
    v_mfma_f32_16x16x32_bf16 v[116:119], a[0:3], a[20:23], v[116:119]
    ds_read_b128 a[24:27], v25 offset:22528
    v_mfma_f32_16x16x32_bf16 v[124:127], a[4:7], a[20:23], v[124:127]
    ds_read_b128 a[28:31], v25 offset:23552
    s_add_u32 s4, s95, 0
    buffer_load_short_d16_hi v96, v8, s[32:35], s4 offen
    buffer_load_short_d16_hi v104, v8, s[36:39], s4 offen
    s_add_u32 s4, s95, 14400
    buffer_load_short_d16_hi v97, v8, s[32:35], s4 offen
    buffer_load_short_d16_hi v105, v8, s[36:39], s4 offen
    s_add_u32 s4, s95, 28800
    buffer_load_short_d16_hi v98, v8, s[32:35], s4 offen
    buffer_load_short_d16_hi v106, v8, s[36:39], s4 offen
    s_add_u32 s4, s95, 43200
    buffer_load_short_d16_hi v99, v8, s[32:35], s4 offen
    buffer_load_short_d16_hi v107, v8, s[36:39], s4 offen
    s_add_u32 s4, s95, 230400
    buffer_load_short_d16_hi v100, v8, s[32:35], s4 offen
    buffer_load_short_d16_hi v108, v8, s[36:39], s4 offen
    s_add_u32 s4, s95, 244800
    buffer_load_short_d16_hi v101, v8, s[32:35], s4 offen
    buffer_load_short_d16_hi v109, v8, s[36:39], s4 offen
    s_add_u32 s4, s95, 259200
    buffer_load_short_d16_hi v102, v8, s[32:35], s4 offen
    buffer_load_short_d16_hi v110, v8, s[36:39], s4 offen
    s_add_u32 s4, s95, 273600
    buffer_load_short_d16_hi v103, v8, s[32:35], s4 offen
    buffer_load_short_d16_hi v111, v8, s[36:39], s4 offen
    s_waitcnt vmcnt(16)
    s_barrier
    s_waitcnt lgkmcnt(0)
    v_mfma_f32_16x16x32_bf16 v[112:115], a[8:11], a[24:27], v[112:115]
    ds_read_b128 a[0:3], v12 offset:32768
    v_mfma_f32_16x16x32_bf16 v[120:123], a[12:15], a[24:27], v[120:123]
    ds_read_b128 a[4:7], v12 offset:34816
    v_mfma_f32_16x16x32_bf16 v[116:119], a[8:11], a[28:31], v[116:119]
    ds_read_b128 a[16:19], v25 offset:24576
    v_mfma_f32_16x16x32_bf16 v[124:127], a[12:15], a[28:31], v[124:127]
    ds_read_b128 a[20:23], v25 offset:25600
    s_add_u32 m0, s72, 108544
    s_mov_b32 exec_hi, 0xffffff
    buffer_load_dwordx4 v23, s[24:27], s74 offen lds
    s_mov_b32 exec_hi, -1
    s_add_u32 s71, s74, 14336
    s_add_u32 m0, s72, 112128
    s_mov_b32 exec_hi, 0xffffff
    buffer_load_dwordx4 v23, s[24:27], s71 offen lds
    s_mov_b32 exec_hi, -1
    s_add_u32 s71, s74, 28672
    s_add_u32 m0, s72, 115712
    s_mov_b32 exec_hi, 0xffffff
    buffer_load_dwordx4 v23, s[24:27], s71 offen lds
    s_mov_b32 exec_hi, -1
    s_add_u32 s71, s74, 43008
    s_add_u32 m0, s72, 119296
    s_mov_b32 exec_hi, 0xffffff
    buffer_load_dwordx4 v23, s[24:27], s71 offen lds
    s_mov_b32 exec_hi, -1
    s_waitcnt lgkmcnt(0)
    v_mfma_f32_16x16x32_bf16 v[112:115], a[0:3], a[16:19], v[112:115]
    ds_read_b128 a[8:11], v13 offset:32768
    v_mfma_f32_16x16x32_bf16 v[120:123], a[4:7], a[16:19], v[120:123]
    ds_read_b128 a[12:15], v13 offset:34816
    v_mfma_f32_16x16x32_bf16 v[116:119], a[0:3], a[20:23], v[116:119]
    ds_read_b128 a[24:27], v25 offset:26624
    v_mfma_f32_16x16x32_bf16 v[124:127], a[4:7], a[20:23], v[124:127]
    ds_read_b128 a[28:31], v25 offset:27648
    s_add_u32 s71, s74, 57344
    s_add_u32 m0, s72, 49152
    s_mov_b32 exec_hi, 0xffffff
    buffer_load_dwordx4 v23, s[24:27], s71 offen lds
    s_mov_b32 exec_hi, -1
    s_add_u32 s71, s74, 71680
    s_add_u32 m0, s72, 52736
    s_mov_b32 exec_hi, 0xffffff
    buffer_load_dwordx4 v23, s[24:27], s71 offen lds
    s_mov_b32 exec_hi, -1
    s_add_u32 m0, s72, 56320
    s_mov_b32 exec_hi, 0xffffff
    buffer_load_dwordx4 v23, s[24:27], s75 offen lds
    s_mov_b32 exec_hi, -1
    s_add_u32 s71, s75, 14336
    s_add_u32 m0, s72, 59904
    s_mov_b32 exec_hi, 0xffffff
    buffer_load_dwordx4 v23, s[24:27], s71 offen lds
    s_mov_b32 exec_hi, -1
    s_waitcnt lgkmcnt(0)
    v_mfma_f32_16x16x32_bf16 v[112:115], a[8:11], a[24:27], v[112:115]
    v_mfma_f32_16x16x32_bf16 v[120:123], a[12:15], a[24:27], v[120:123]
    v_mfma_f32_16x16x32_bf16 v[116:119], a[8:11], a[28:31], v[116:119]
    v_mfma_f32_16x16x32_bf16 v[124:127], a[12:15], a[28:31], v[124:127]
    s_setprio 1
    s_nop 4
    s_cmp_eq_u32 s45, 15
    s_cbranch_scc1 L_gate
    v_cvt_pk_bf16_f32 v160, v112, v116
    v_cvt_pk_bf16_f32 v161, v113, v117
    v_cvt_pk_bf16_f32 v162, v114, v118
    v_cvt_pk_bf16_f32 v163, v115, v119
    v_cvt_pk_bf16_f32 v164, v120, v124
    v_cvt_pk_bf16_f32 v165, v121, v125
    v_cvt_pk_bf16_f32 v166, v122, v126
    v_cvt_pk_bf16_f32 v167, v123, v127
    v_mfma_f32_16x16x32_bf16 v[168:171], v[128:131], v[160:163], 0
    v_mfma_f32_16x16x32_bf16 v[176:179], v[144:147], v[160:163], 0
    v_mfma_f32_16x16x32_bf16 v[172:175], v[136:139], v[160:163], 0
    v_mfma_f32_16x16x32_bf16 v[180:183], v[152:155], v[160:163], 0
    v_mfma_f32_16x16x32_bf16 v[168:171], v[132:135], v[164:167], v[168:171]
    v_mfma_f32_16x16x32_bf16 v[176:179], v[148:151], v[164:167], v[176:179]
    v_mfma_f32_16x16x32_bf16 v[172:175], v[140:143], v[164:167], v[172:175]
    v_mfma_f32_16x16x32_bf16 v[180:183], v[156:159], v[164:167], v[180:183]
    s_nop 5
    v_cvt_pk_bf16_f32 v168, v168, v176
    ds_write_b32 v5, v168 offset:0
    v_cvt_pk_bf16_f32 v169, v169, v177
    ds_write_b32 v5, v169 offset:256
    v_cvt_pk_bf16_f32 v170, v170, v178
    ds_write_b32 v5, v170 offset:512
    v_cvt_pk_bf16_f32 v171, v171, v179
    ds_write_b32 v5, v171 offset:768
    v_cvt_pk_bf16_f32 v172, v172, v180
    ds_write_b32 v5, v172 offset:4096
    v_cvt_pk_bf16_f32 v173, v173, v181
    ds_write_b32 v5, v173 offset:4352
    v_cvt_pk_bf16_f32 v174, v174, v182
    ds_write_b32 v5, v174 offset:4608
    v_cvt_pk_bf16_f32 v175, v175, v183
    ds_write_b32 v5, v175 offset:4864
    ds_write_b32 v19, v17 offset:16
lw8:
    ds_read_b32 v5, v16 offset:16
    s_waitcnt lgkmcnt(0)
    v_cmp_ne_u32 vcc, 1, v5
    s_nop 1
    s_cbranch_vccnz lw8
    ds_read_b128 v[112:115], v6 offset:0
    ds_read_b128 v[120:123], v6 offset:4096
    s_waitcnt lgkmcnt(0)
L_a1st:
    buffer_store_dwordx4 v[112:115], v30, s[28:31], s88 offen sc1
    buffer_store_dwordx4 v[120:123], v30, s[28:31], s89 offen sc1
    s_setprio 1
    s_setprio 1
    s_waitcnt vmcnt(2)
    ds_write_b32 v19, v17 offset:96
    s_waitcnt vmcnt(0)
    s_atomic_swap s7, s[28:29], s94
lw9:
    ds_read_b32 v8, v16 offset:144
    s_waitcnt lgkmcnt(0)
    v_cmp_ne_u32 vcc, 1, v8
    s_nop 1
    s_cbranch_vccnz lw9
    v_mul_u32_u24 v14, 147712, v3
    v_lshl_add_u32 v14, v4, 4, v14
    s_min_u32 s5, s84, 14
    s_mul_i32 s4, s5, 8960
    s_mul_i32 s3, s48, 128
    s_add_u32 s4, s4, s3
    s_mul_i32 s3, s8, 590848
    s_add_u32 s4, s4, s3
    s_add_u32 s4, s4, 0x1402000
    s_setprio 1
    s_setprio 1
    s_mov_b32 s6, 0
    s_load_dword s64, s[28:29], s4 offset:0 glc
    s_load_dword s65, s[28:29], s4 offset:147712 glc
    s_load_dword s66, s[28:29], s4 offset:295424 glc
    s_load_dword s67, s[28:29], s4 offset:443136 glc
    s_branch chk10
rty10:
    s_add_u32 s6, s6, 1
    s_cmp_ge_u32 s6, 500000
    s_cbranch_scc1 back10
    s_sleep 2
    s_load_dword s64, s[28:29], s4 offset:0 glc
    s_load_dword s65, s[28:29], s4 offset:147712 glc
    s_load_dword s66, s[28:29], s4 offset:295424 glc
    s_load_dword s67, s[28:29], s4 offset:443136 glc
chk10:
    s_waitcnt lgkmcnt(0)
    s_xor_b32 s64, s64, s7
    s_xor_b32 s65, s65, s7
    s_or_b32 s64, s64, s65
    s_xor_b32 s66, s66, s7
    s_or_b32 s64, s64, s66
    s_xor_b32 s67, s67, s7
    s_or_b32 s64, s64, s67
    s_cbranch_scc1 rty10
back10:
    ds_write_b32 v19, v17 offset:128
lw11:
    ds_read_b32 v8, v16 offset:128
    s_waitcnt lgkmcnt(0)
    v_cmp_ne_u32 vcc, 1, v8
    s_nop 1
    s_cbranch_vccnz lw11
    s_add_u32 s4, s96, 0x0
    buffer_load_dwordx4 v[112:115], v14, s[28:31], s4 offen sc1
    s_add_u32 s4, s96, 0x90400
    buffer_load_dwordx4 v[116:119], v14, s[28:31], s4 offen sc1
    s_add_u32 s4, s96, 0x120800
    buffer_load_dwordx4 v[120:123], v14, s[28:31], s4 offen sc1
    s_add_u32 s4, s96, 0x1b0c00
    buffer_load_dwordx4 v[124:127], v14, s[28:31], s4 offen sc1
    s_mul_i32 s56, s48, 128
    s_mul_i32 s3, s44, 147712
    s_add_u32 s56, s56, s3
    s_add_u32 s56, s56, 0x1422d00
    s_mov_b32 s6, 0
    s_load_dword s64, s[28:29], s56 offset:0 glc
    v_lshlrev_b32 v161, 2, v3
    v_cvt_f32_u32 v161, v161
    v_lshl_add_u32 v160, v4, 6, s52
    v_cvt_f32_u32 v160, v160
    v_mul_f32 v160, 0x3a000000, v160
    v_add_f32 v162, 0x00000000, v161
    v_mul_f32 v162, v162, v160
    v_cos_f32 v163, v162
    v_sin_f32 v164, v162
    s_nop 0
    v_cvt_pk_bf16_f32 v165, v163, -v164
    v_cvt_pk_bf16_f32 v166, v164, v163
    v_accvgpr_write_b32 a32, v165
    v_accvgpr_write_b32 a48, v166
    v_accvgpr_write_b32 a40, v165
    v_accvgpr_write_b32 a56, v166
    v_add_f32 v162, 0x3f800000, v161
    v_mul_f32 v162, v162, v160
    v_cos_f32 v163, v162
    v_sin_f32 v164, v162
    s_nop 0
    v_cvt_pk_bf16_f32 v165, v163, -v164
    v_cvt_pk_bf16_f32 v166, v164, v163
    v_accvgpr_write_b32 a33, v165
    v_accvgpr_write_b32 a49, v166
    v_cvt_pk_bf16_f32 v165, -v163, v164
    v_cvt_pk_bf16_f32 v166, -v164, -v163
    v_accvgpr_write_b32 a41, v165
    v_accvgpr_write_b32 a57, v166
    v_add_f32 v162, 0x40000000, v161
    v_mul_f32 v162, v162, v160
    v_cos_f32 v163, v162
    v_sin_f32 v164, v162
    s_nop 0
    v_cvt_pk_bf16_f32 v165, v163, -v164
    v_cvt_pk_bf16_f32 v166, v164, v163
    v_accvgpr_write_b32 a34, v165
    v_accvgpr_write_b32 a50, v166
    v_accvgpr_write_b32 a42, v165
    v_accvgpr_write_b32 a58, v166
    v_add_f32 v162, 0x40400000, v161
    v_mul_f32 v162, v162, v160
    v_cos_f32 v163, v162
    v_sin_f32 v164, v162
    s_nop 0
    v_cvt_pk_bf16_f32 v165, v163, -v164
    v_cvt_pk_bf16_f32 v166, v164, v163
    v_accvgpr_write_b32 a35, v165
    v_accvgpr_write_b32 a51, v166
    v_cvt_pk_bf16_f32 v165, -v163, v164
    v_cvt_pk_bf16_f32 v166, -v164, -v163
    v_accvgpr_write_b32 a43, v165
    v_accvgpr_write_b32 a59, v166
    v_add_f32 v162, 0x41800000, v161
    v_mul_f32 v162, v162, v160
    v_cos_f32 v163, v162
    v_sin_f32 v164, v162
    s_nop 0
    v_cvt_pk_bf16_f32 v165, v163, -v164
    v_cvt_pk_bf16_f32 v166, v164, v163
    v_accvgpr_write_b32 a36, v165
    v_accvgpr_write_b32 a52, v166
    v_accvgpr_write_b32 a44, v165
    v_accvgpr_write_b32 a60, v166
    v_add_f32 v162, 0x41880000, v161
    v_mul_f32 v162, v162, v160
    v_cos_f32 v163, v162
    v_sin_f32 v164, v162
    s_nop 0
    v_cvt_pk_bf16_f32 v165, v163, -v164
    v_cvt_pk_bf16_f32 v166, v164, v163
    v_accvgpr_write_b32 a37, v165
    v_accvgpr_write_b32 a53, v166
    v_cvt_pk_bf16_f32 v165, -v163, v164
    v_cvt_pk_bf16_f32 v166, -v164, -v163
    v_accvgpr_write_b32 a45, v165
    v_accvgpr_write_b32 a61, v166
    v_add_f32 v162, 0x41900000, v161
    v_mul_f32 v162, v162, v160
    v_cos_f32 v163, v162
    v_sin_f32 v164, v162
    s_nop 0
    v_cvt_pk_bf16_f32 v165, v163, -v164
    v_cvt_pk_bf16_f32 v166, v164, v163
    v_accvgpr_write_b32 a38, v165
    v_accvgpr_write_b32 a54, v166
    v_accvgpr_write_b32 a46, v165
    v_accvgpr_write_b32 a62, v166
    v_add_f32 v162, 0x41980000, v161
    v_mul_f32 v162, v162, v160
    v_cos_f32 v163, v162
    v_sin_f32 v164, v162
    s_nop 0
    v_cvt_pk_bf16_f32 v165, v163, -v164
    v_cvt_pk_bf16_f32 v166, v164, v163
    v_accvgpr_write_b32 a39, v165
    v_accvgpr_write_b32 a55, v166
    v_cvt_pk_bf16_f32 v165, -v163, v164
    v_cvt_pk_bf16_f32 v166, -v164, -v163
    v_accvgpr_write_b32 a47, v165
    v_accvgpr_write_b32 a63, v166
    s_branch chk12
rty12:
    s_add_u32 s6, s6, 1
    s_cmp_ge_u32 s6, 500000
    s_cbranch_scc1 back12
    s_sleep 2
    s_load_dword s64, s[28:29], s56 offset:0 glc
chk12:
    s_waitcnt lgkmcnt(0)
    s_xor_b32 s64, s64, s7
    s_cbranch_scc1 rty12
back12:
    v_lshlrev_b32 v24, 2, v4
    buffer_load_dword v26, v24, s[28:31], s99 offen offset:0 sc1
    buffer_load_dword v27, v24, s[28:31], s99 offen offset:64 sc1
    s_and_b32 s4, s8, 1
    s_lshl_b32 s5, s4, 12
    s_add_u32 s5, s5, 40960
    v_add_u32 v6, s5, v9
    s_lshl_b32 s5, s86, 11
    v_add_u32 v5, s5, v6
    s_lshl_b32 s4, s4, 2
    s_lshl_b32 s5, s86, 12
    s_add_u32 s4, s4, s5
    s_add_u32 s4, s4, 32768
    v_lshl_add_u32 v7, v3, 9, s4
    v_lshl_add_u32 v7, v4, 3, v7
    s_waitcnt vmcnt(2)
    v_mfma_f32_16x16x32_bf16 v[128:131], v[32:35], v[112:115], 0
    v_mfma_f32_16x16x32_bf16 v[136:139], v[64:67], v[112:115], 0
    v_mfma_f32_16x16x32_bf16 v[128:131], v[36:39], v[116:119], v[128:131]
    v_mfma_f32_16x16x32_bf16 v[136:139], v[68:71], v[116:119], v[136:139]
    v_mfma_f32_16x16x32_bf16 v[128:131], v[40:43], v[120:123], v[128:131]
    v_mfma_f32_16x16x32_bf16 v[136:139], v[72:75], v[120:123], v[136:139]
    v_mfma_f32_16x16x32_bf16 v[128:131], v[44:47], v[124:127], v[128:131]
    v_mfma_f32_16x16x32_bf16 v[136:139], v[76:79], v[124:127], v[136:139]
    v_mfma_f32_16x16x32_bf16 v[132:135], v[48:51], v[112:115], 0
    v_mfma_f32_16x16x32_bf16 v[140:143], v[80:83], v[112:115], 0
    v_mfma_f32_16x16x32_bf16 v[132:135], v[52:55], v[116:119], v[132:135]
    v_mfma_f32_16x16x32_bf16 v[140:143], v[84:87], v[116:119], v[140:143]
    s_nop 2
    v_mul_f32 v152, v128, v96
    v_mul_f32 v156, v128, v104
    v_mfma_f32_16x16x32_bf16 v[132:135], v[56:59], v[120:123], v[132:135]
    v_fma_f32 v152, -v136, v104, v152
    v_fma_f32 v156, v136, v96, v156
    v_mfma_f32_16x16x32_bf16 v[140:143], v[88:91], v[120:123], v[140:143]
    v_cvt_pk_bf16_f32 v144, v156, v152
    v_mul_f32 v153, v129, v97
    v_mfma_f32_16x16x32_bf16 v[132:135], v[60:63], v[124:127], v[132:135]
    v_mul_f32 v157, v129, v105
    v_fma_f32 v153, -v137, v105, v153
    v_mfma_f32_16x16x32_bf16 v[140:143], v[92:95], v[124:127], v[140:143]
    v_fma_f32 v157, v137, v97, v157
    v_cvt_pk_bf16_f32 v145, v157, v153
    v_mul_f32 v154, v130, v98
    v_mul_f32 v158, v130, v106
    v_fma_f32 v154, -v138, v106, v154
    v_fma_f32 v158, v138, v98, v158
    v_cvt_pk_bf16_f32 v146, v158, v154
    v_mul_f32 v155, v131, v99
    v_mul_f32 v159, v131, v107
    v_fma_f32 v155, -v139, v107, v155
    v_fma_f32 v159, v139, v99, v159
    v_cvt_pk_bf16_f32 v147, v159, v155
    ds_write_b128 v5, v[144:147] offset:0
    v_mul_f32 v152, v132, v100
    v_mul_f32 v156, v132, v108
    v_fma_f32 v152, -v140, v108, v152
    v_fma_f32 v156, v140, v100, v156
    v_cvt_pk_bf16_f32 v148, v156, v152
    v_mul_f32 v153, v133, v101
    v_mul_f32 v157, v133, v109
    v_fma_f32 v153, -v141, v109, v153
    v_fma_f32 v157, v141, v101, v157
    v_cvt_pk_bf16_f32 v149, v157, v153
    v_mul_f32 v154, v134, v102
    v_mul_f32 v158, v134, v110
    v_fma_f32 v154, -v142, v110, v154
    v_fma_f32 v158, v142, v102, v158
    v_cvt_pk_bf16_f32 v150, v158, v154
    v_mul_f32 v155, v135, v103
    v_mul_f32 v159, v135, v111
    v_fma_f32 v155, -v143, v111, v155
    v_fma_f32 v159, v143, v103, v159
    v_cvt_pk_bf16_f32 v151, v159, v155
    ds_write_b128 v5, v[148:151] offset:1024
    ds_write_b32 v19, v17 offset:32
    v_xor_b32 v15, 8, v19
lw13:
    ds_read_b32 v8, v15 offset:32
    s_waitcnt lgkmcnt(0)
    v_cmp_ne_u32 vcc, 1, v8
    s_nop 1
    s_cbranch_vccnz lw13
    ds_read_b128 v[112:115], v6 offset:0
    ds_read_b128 v[116:119], v6 offset:1024
    ds_read_b128 v[120:123], v6 offset:2048
    ds_read_b128 v[124:127], v6 offset:3072
    s_lshl_b32 s4, s8, 11
    s_add_u32 s4, s4, 32768
    v_add_u32 v6, s4, v9
    v_lshrrev_b32 v5, 3, v2
    v_and_b32 v8, 7, v2
    v_mul_u32_u24 v5, 2432, v5
    v_lshl_add_u32 v5, v8, 4, v5
    s_add_u32 s4, s97, 19456
    s_waitcnt lgkmcnt(0)
    v_mfma_f32_16x16x32_bf16 v[128:131], v[64:67], v[112:115], 0
    v_mfma_f32_16x16x32_bf16 v[136:139], v[32:35], v[112:115], 0
    v_mfma_f32_16x16x32_bf16 v[128:131], v[68:71], v[116:119], v[128:131]
    v_mfma_f32_16x16x32_bf16 v[136:139], v[36:39], v[116:119], v[136:139]
    v_mfma_f32_16x16x32_bf16 v[128:131], v[72:75], v[120:123], v[128:131]
    v_mfma_f32_16x16x32_bf16 v[136:139], v[40:43], v[120:123], v[136:139]
    v_mfma_f32_16x16x32_bf16 v[128:131], v[76:79], v[124:127], v[128:131]
    v_mfma_f32_16x16x32_bf16 v[136:139], v[44:47], v[124:127], v[136:139]
    v_mfma_f32_16x16x32_bf16 v[132:135], v[80:83], v[112:115], 0
    v_mfma_f32_16x16x32_bf16 v[140:143], v[48:51], v[112:115], 0
    v_mfma_f32_16x16x32_bf16 v[132:135], v[84:87], v[116:119], v[132:135]
    v_mfma_f32_16x16x32_bf16 v[140:143], v[52:55], v[116:119], v[140:143]
    v_mfma_f32_16x16x32_bf16 v[132:135], v[88:91], v[120:123], v[132:135]
    s_nop 2
    v_cvt_pk_bf16_f32 v144, v128, v136
    ds_write_b32 v7, v144 offset:0
    v_mfma_f32_16x16x32_bf16 v[140:143], v[56:59], v[120:123], v[140:143]
    v_cvt_pk_bf16_f32 v145, v129, v137
    ds_write_b32 v7, v145 offset:128
    v_mfma_f32_16x16x32_bf16 v[132:135], v[92:95], v[124:127], v[132:135]
    v_cvt_pk_bf16_f32 v146, v130, v138
    ds_write_b32 v7, v146 offset:256
    v_mfma_f32_16x16x32_bf16 v[140:143], v[60:63], v[124:127], v[140:143]
    v_cvt_pk_bf16_f32 v147, v131, v139
    ds_write_b32 v7, v147 offset:384
    s_nop 5
    v_cvt_pk_bf16_f32 v148, v132, v140
    ds_write_b32 v7, v148 offset:2048
    v_cvt_pk_bf16_f32 v149, v133, v141
    ds_write_b32 v7, v149 offset:2176
    v_cvt_pk_bf16_f32 v150, v134, v142
    ds_write_b32 v7, v150 offset:2304
    v_cvt_pk_bf16_f32 v151, v135, v143
    ds_write_b32 v7, v151 offset:2432
    ds_write_b32 v19, v17 offset:48
lw14:
    ds_read_b32 v8, v16 offset:48
    s_waitcnt lgkmcnt(0)
    v_cmp_ne_u32 vcc, 1, v8
    s_nop 1
    s_cbranch_vccnz lw14
    ds_read_b128 v[152:155], v6 offset:0
    ds_read_b128 v[156:159], v6 offset:1024
    s_waitcnt lgkmcnt(1)
    buffer_store_dwordx4 v[152:155], v5, s[28:31], s97 offen sc1
    s_waitcnt lgkmcnt(0)
    buffer_store_dwordx4 v[156:159], v5, s[28:31], s4 offen sc1
    v_lshlrev_b32 v5, 8, v3
    v_lshl_add_u32 v5, v4, 3, v5
    v_mul_u32_u24 v14, 2432, v4
    s_setprio 0
    s_mul_i32 s56, s49, 112
    s_mul_i32 s57, s8, 32
    s_add_u32 s56, s56, s57
    v_add_u32 v172, s56, v4
    v_cvt_f32_u32 v172, v172
    v_lshlrev_b32 v174, 2, v3
    v_cvt_f32_u32 v174, v174
    v_mul_f32 v173, s54, v172
    v_mul_f32 v175, v174, v173
    v_mul_f32 v8, 0x41800000, v173
    v_cos_f32 v168, v173
    v_cos_f32 v170, v8
    v_add_f32 v176, v175, v173
    v_add_f32 v177, v175, v8
    v_add_f32 v178, v176, v8
    v_add_f32 v168, v168, v168
    v_add_f32 v170, v170, v170
    v_cos_f32 v152, v175
    v_sin_f32 v153, -v175
    v_cos_f32 v154, v176
    v_sin_f32 v155, -v176
    v_cos_f32 v160, v177
    v_sin_f32 v161, -v177
    v_cos_f32 v162, v178
    v_sin_f32 v163, -v178
    v_fma_f32 v156, v168, v154, -v152
    v_fma_f32 v157, v168, v155, -v153
    v_fma_f32 v164, v168, v162, -v160
    v_fma_f32 v165, v168, v163, -v161
    v_fma_f32 v158, v168, v156, -v154
    v_fma_f32 v159, v168, v157, -v155
    v_fma_f32 v166, v168, v164, -v162
    v_fma_f32 v167, v168, v165, -v163
    v_cvt_pk_bf16_f32 v32, v152, v153
    v_cvt_pk_bf16_f32 v33, v154, v155
    v_cvt_pk_bf16_f32 v34, v156, v157
    v_cvt_pk_bf16_f32 v35, v158, v159
    v_cvt_pk_bf16_f32 v40, v160, v161
    v_cvt_pk_bf16_f32 v41, v162, v163
    v_cvt_pk_bf16_f32 v42, v164, v165
    v_cvt_pk_bf16_f32 v43, v166, v167
    v_fma_f32 v152, v170, v160, -v152
    v_fma_f32 v153, v170, v161, -v153
    v_fma_f32 v154, v170, v162, -v154
    v_fma_f32 v155, v170, v163, -v155
    v_fma_f32 v156, v170, v164, -v156
    s_waitcnt vmcnt(0)
    s_mov_b64 exec, 0xffff
    buffer_atomic_add v17, v14, s[28:31], s90 offen sc1
    s_mov_b64 exec, -1
    s_andn2_b32 s5, s52, 0
    s_mul_i32 s94, s5, 2432
    s_mul_i32 s3, s8, 640000
    s_add_u32 s94, s94, s3
    s_add_u32 s94, s94, 0x1920800
    s_cmp_eq_u32 s8, 3
    s_cselect_b32 s5, 0, 1
    s_mul_i32 s5, s5, 480000
    s_add_u32 s5, s5, s94
    s_add_u32 s92, s7, 16
    v_fma_f32 v157, v170, v165, -v157
    v_fma_f32 v158, v170, v166, -v158
    v_fma_f32 v159, v170, v167, -v159
    v_cvt_pk_bf16_f32 v48, v152, v153
    v_cvt_pk_bf16_f32 v49, v154, v155
    v_cvt_pk_bf16_f32 v50, v156, v157
    v_cvt_pk_bf16_f32 v51, v158, v159
    v_fma_f32 v160, v170, v152, -v160
    v_fma_f32 v161, v170, v153, -v161
    v_fma_f32 v162, v170, v154, -v162
    v_fma_f32 v163, v170, v155, -v163
    v_fma_f32 v164, v170, v156, -v164
    v_fma_f32 v165, v170, v157, -v165
    v_fma_f32 v166, v170, v158, -v166
    v_fma_f32 v167, v170, v159, -v167
    v_cvt_pk_bf16_f32 v56, v160, v161
    v_cvt_pk_bf16_f32 v57, v162, v163
    v_cvt_pk_bf16_f32 v58, v164, v165
    v_cvt_pk_bf16_f32 v59, v166, v167
    v_fma_f32 v152, v170, v160, -v152
    v_fma_f32 v153, v170, v161, -v153
    v_fma_f32 v154, v170, v162, -v154
    v_fma_f32 v155, v170, v163, -v155
    v_fma_f32 v156, v170, v164, -v156
    v_fma_f32 v157, v170, v165, -v157
    v_fma_f32 v158, v170, v166, -v158
    v_fma_f32 v159, v170, v167, -v159
    v_cvt_pk_bf16_f32 v64, v152, v153
    v_cvt_pk_bf16_f32 v65, v154, v155
    v_cvt_pk_bf16_f32 v66, v156, v157
    v_cvt_pk_bf16_f32 v67, v158, v159
    v_fma_f32 v160, v170, v152, -v160
    v_fma_f32 v161, v170, v153, -v161
    v_fma_f32 v162, v170, v154, -v162
    v_fma_f32 v163, v170, v155, -v163
    v_fma_f32 v164, v170, v156, -v164
    v_fma_f32 v165, v170, v157, -v165
    v_fma_f32 v166, v170, v158, -v166
    v_fma_f32 v167, v170, v159, -v167
    v_cvt_pk_bf16_f32 v72, v160, v161
    v_cvt_pk_bf16_f32 v73, v162, v163
    v_cvt_pk_bf16_f32 v74, v164, v165
    v_cvt_pk_bf16_f32 v75, v166, v167
    v_fma_f32 v152, v170, v160, -v152
    v_fma_f32 v153, v170, v161, -v153
    v_fma_f32 v154, v170, v162, -v154
    v_fma_f32 v155, v170, v163, -v155
    v_fma_f32 v156, v170, v164, -v156
    v_fma_f32 v157, v170, v165, -v157
    v_fma_f32 v158, v170, v166, -v158
    v_fma_f32 v159, v170, v167, -v159
    v_cvt_pk_bf16_f32 v80, v152, v153
    v_cvt_pk_bf16_f32 v81, v154, v155
    v_cvt_pk_bf16_f32 v82, v156, v157
    v_cvt_pk_bf16_f32 v83, v158, v159
    v_fma_f32 v160, v170, v152, -v160
    v_fma_f32 v161, v170, v153, -v161
    v_fma_f32 v162, v170, v154, -v162
    v_fma_f32 v163, v170, v155, -v163
    v_fma_f32 v164, v170, v156, -v164
    v_fma_f32 v165, v170, v157, -v165
    v_fma_f32 v166, v170, v158, -v166
    v_fma_f32 v167, v170, v159, -v167
    v_cvt_pk_bf16_f32 v88, v160, v161
    v_cvt_pk_bf16_f32 v89, v162, v163
    v_cvt_pk_bf16_f32 v90, v164, v165
    v_cvt_pk_bf16_f32 v91, v166, v167
    v_fma_f32 v152, v170, v160, -v152
    v_fma_f32 v153, v170, v161, -v153
    v_fma_f32 v154, v170, v162, -v154
    v_fma_f32 v155, v170, v163, -v155
    v_fma_f32 v156, v170, v164, -v156
    v_fma_f32 v157, v170, v165, -v157
    v_fma_f32 v158, v170, v166, -v158
    v_fma_f32 v159, v170, v167, -v159
    v_cvt_pk_bf16_f32 v96, v152, v153
    v_cvt_pk_bf16_f32 v97, v154, v155
    v_cvt_pk_bf16_f32 v98, v156, v157
    v_cvt_pk_bf16_f32 v99, v158, v159
    v_fma_f32 v160, v170, v152, -v160
    v_fma_f32 v161, v170, v153, -v161
    v_fma_f32 v162, v170, v154, -v162
    v_fma_f32 v163, v170, v155, -v163
    v_fma_f32 v164, v170, v156, -v164
    v_fma_f32 v165, v170, v157, -v165
    v_fma_f32 v166, v170, v158, -v166
    v_fma_f32 v167, v170, v159, -v167
    v_cvt_pk_bf16_f32 v104, v160, v161
    v_cvt_pk_bf16_f32 v105, v162, v163
    v_cvt_pk_bf16_f32 v106, v164, v165
    v_cvt_pk_bf16_f32 v107, v166, v167
    v_fma_f32 v152, v170, v160, -v152
    v_fma_f32 v153, v170, v161, -v153
    v_fma_f32 v154, v170, v162, -v154
    v_fma_f32 v155, v170, v163, -v155
    v_fma_f32 v156, v170, v164, -v156
    v_fma_f32 v157, v170, v165, -v157
    v_fma_f32 v158, v170, v166, -v158
    v_fma_f32 v159, v170, v167, -v159
    v_cvt_pk_bf16_f32 v112, v152, v153
    v_cvt_pk_bf16_f32 v113, v154, v155
    v_cvt_pk_bf16_f32 v114, v156, v157
    v_cvt_pk_bf16_f32 v115, v158, v159
    v_fma_f32 v160, v170, v152, -v160
    v_fma_f32 v161, v170, v153, -v161
    v_fma_f32 v162, v170, v154, -v162
    v_fma_f32 v163, v170, v155, -v163
    v_fma_f32 v164, v170, v156, -v164
    v_fma_f32 v165, v170, v157, -v165
    v_fma_f32 v166, v170, v158, -v166
    v_fma_f32 v167, v170, v159, -v167
    v_cvt_pk_bf16_f32 v120, v160, v161
    v_cvt_pk_bf16_f32 v121, v162, v163
    v_cvt_pk_bf16_f32 v122, v164, v165
    v_cvt_pk_bf16_f32 v123, v166, v167
    v_fma_f32 v152, v170, v160, -v152
    v_fma_f32 v153, v170, v161, -v153
    v_fma_f32 v154, v170, v162, -v154
    v_fma_f32 v155, v170, v163, -v155
    v_fma_f32 v156, v170, v164, -v156
    v_fma_f32 v157, v170, v165, -v157
    v_fma_f32 v158, v170, v166, -v158
    v_fma_f32 v159, v170, v167, -v159
    v_cvt_pk_bf16_f32 v128, v152, v153
    v_cvt_pk_bf16_f32 v129, v154, v155
    v_cvt_pk_bf16_f32 v130, v156, v157
    v_cvt_pk_bf16_f32 v131, v158, v159
    v_fma_f32 v160, v170, v152, -v160
    v_fma_f32 v161, v170, v153, -v161
    v_fma_f32 v162, v170, v154, -v162
    v_fma_f32 v163, v170, v155, -v163
    v_fma_f32 v164, v170, v156, -v164
    v_fma_f32 v165, v170, v157, -v165
    v_fma_f32 v166, v170, v158, -v166
    v_fma_f32 v167, v170, v159, -v167
    v_cvt_pk_bf16_f32 v136, v160, v161
    v_cvt_pk_bf16_f32 v137, v162, v163
    v_cvt_pk_bf16_f32 v138, v164, v165
    v_cvt_pk_bf16_f32 v139, v166, v167
    v_fma_f32 v152, v170, v160, -v152
    v_fma_f32 v153, v170, v161, -v153
    v_fma_f32 v154, v170, v162, -v154
    v_fma_f32 v155, v170, v163, -v155
    v_fma_f32 v156, v170, v164, -v156
    v_fma_f32 v157, v170, v165, -v157
    v_fma_f32 v158, v170, v166, -v158
    v_fma_f32 v159, v170, v167, -v159
    v_cvt_pk_bf16_f32 v144, v152, v153
    s_mov_b32 s6, 0
    s_load_dword s64, s[28:29], s94 offset:0 glc
    s_load_dword s65, s[28:29], s94 offset:160000 glc
    s_load_dword s66, s[28:29], s94 offset:320000 glc
    s_load_dword s67, s[28:29], s5 offset:0 glc
    v_cvt_pk_bf16_f32 v145, v154, v155
    v_cvt_pk_bf16_f32 v146, v156, v157
    v_cvt_pk_bf16_f32 v147, v158, v159
    v_add_f32 v172, 0x41800000, v172
    v_mul_f32 v173, s54, v172
    v_mul_f32 v175, v174, v173
    v_mul_f32 v8, 0x41800000, v173
    v_cos_f32 v168, v173
    v_cos_f32 v170, v8
    v_add_f32 v176, v175, v173
    v_add_f32 v177, v175, v8
    v_add_f32 v178, v176, v8
    v_add_f32 v168, v168, v168
    v_add_f32 v170, v170, v170
    v_cos_f32 v152, v175
    v_sin_f32 v153, -v175
    v_cos_f32 v154, v176
    v_sin_f32 v155, -v176
    v_cos_f32 v160, v177
    v_sin_f32 v161, -v177
    v_cos_f32 v162, v178
    v_sin_f32 v163, -v178
    v_fma_f32 v156, v168, v154, -v152
    v_fma_f32 v157, v168, v155, -v153
    v_fma_f32 v164, v168, v162, -v160
    v_fma_f32 v165, v168, v163, -v161
    v_fma_f32 v158, v168, v156, -v154
    v_fma_f32 v159, v168, v157, -v155
    v_fma_f32 v166, v168, v164, -v162
    v_fma_f32 v167, v168, v165, -v163
    v_cvt_pk_bf16_f32 v36, v152, v153
    v_cvt_pk_bf16_f32 v37, v154, v155
    v_cvt_pk_bf16_f32 v38, v156, v157
    v_cvt_pk_bf16_f32 v39, v158, v159
    v_cvt_pk_bf16_f32 v44, v160, v161
    v_cvt_pk_bf16_f32 v45, v162, v163
    v_cvt_pk_bf16_f32 v46, v164, v165
    v_cvt_pk_bf16_f32 v47, v166, v167
    v_fma_f32 v152, v170, v160, -v152
    v_fma_f32 v153, v170, v161, -v153
    v_fma_f32 v154, v170, v162, -v154
    v_fma_f32 v155, v170, v163, -v155
    v_fma_f32 v156, v170, v164, -v156
    v_fma_f32 v157, v170, v165, -v157
    v_fma_f32 v158, v170, v166, -v158
    v_fma_f32 v159, v170, v167, -v159
    v_cvt_pk_bf16_f32 v52, v152, v153
    v_cvt_pk_bf16_f32 v53, v154, v155
    v_cvt_pk_bf16_f32 v54, v156, v157
    v_cvt_pk_bf16_f32 v55, v158, v159
    v_fma_f32 v160, v170, v152, -v160
    v_fma_f32 v161, v170, v153, -v161
    v_fma_f32 v162, v170, v154, -v162
    v_fma_f32 v163, v170, v155, -v163
    v_fma_f32 v164, v170, v156, -v164
    v_fma_f32 v165, v170, v157, -v165
    v_fma_f32 v166, v170, v158, -v166
    v_fma_f32 v167, v170, v159, -v167
    v_cvt_pk_bf16_f32 v60, v160, v161
    v_cvt_pk_bf16_f32 v61, v162, v163
    v_cvt_pk_bf16_f32 v62, v164, v165
    v_cvt_pk_bf16_f32 v63, v166, v167
    v_fma_f32 v152, v170, v160, -v152
    v_fma_f32 v153, v170, v161, -v153
    v_fma_f32 v154, v170, v162, -v154
    v_fma_f32 v155, v170, v163, -v155
    v_fma_f32 v156, v170, v164, -v156
    v_fma_f32 v157, v170, v165, -v157
    v_fma_f32 v158, v170, v166, -v158
    v_fma_f32 v159, v170, v167, -v159
    v_cvt_pk_bf16_f32 v68, v152, v153
    v_cvt_pk_bf16_f32 v69, v154, v155
    v_cvt_pk_bf16_f32 v70, v156, v157
    v_cvt_pk_bf16_f32 v71, v158, v159
    v_fma_f32 v160, v170, v152, -v160
    v_fma_f32 v161, v170, v153, -v161
    v_fma_f32 v162, v170, v154, -v162
    v_fma_f32 v163, v170, v155, -v163
    v_fma_f32 v164, v170, v156, -v164
    v_fma_f32 v165, v170, v157, -v165
    v_fma_f32 v166, v170, v158, -v166
    v_fma_f32 v167, v170, v159, -v167
    v_cvt_pk_bf16_f32 v76, v160, v161
    v_cvt_pk_bf16_f32 v77, v162, v163
    v_cvt_pk_bf16_f32 v78, v164, v165
    v_cvt_pk_bf16_f32 v79, v166, v167
    v_fma_f32 v152, v170, v160, -v152
    v_fma_f32 v153, v170, v161, -v153
    v_fma_f32 v154, v170, v162, -v154
    v_fma_f32 v155, v170, v163, -v155
    v_fma_f32 v156, v170, v164, -v156
    v_fma_f32 v157, v170, v165, -v157
    v_fma_f32 v158, v170, v166, -v158
    v_fma_f32 v159, v170, v167, -v159
    v_cvt_pk_bf16_f32 v84, v152, v153
    v_cvt_pk_bf16_f32 v85, v154, v155
    v_cvt_pk_bf16_f32 v86, v156, v157
    s_branch chk15
rty15:
    s_add_u32 s6, s6, 1
    s_cmp_ge_u32 s6, 500000
    s_cbranch_scc1 back15
    s_sleep 2
    s_load_dword s64, s[28:29], s94 offset:0 glc
    s_load_dword s65, s[28:29], s94 offset:160000 glc
    s_load_dword s66, s[28:29], s94 offset:320000 glc
    s_load_dword s67, s[28:29], s5 offset:0 glc
chk15:
    s_waitcnt lgkmcnt(0)
    s_xor_b32 s64, s64, s92
    s_xor_b32 s65, s65, s92
    s_or_b32 s64, s64, s65
    s_xor_b32 s66, s66, s92
    s_or_b32 s64, s64, s66
    s_xor_b32 s67, s67, s92
    s_or_b32 s64, s64, s67
    s_cbranch_scc1 rty15
back15:
    s_add_u32 s4, s98, 0x0
    buffer_load_dwordx2 a[0:1], v5, s[28:31], s4 offen offset:0 sc1
    buffer_load_dwordx2 a[2:3], v5, s[28:31], s4 offen offset:128 sc1
    buffer_load_dwordx2 a[4:5], v5, s[28:31], s4 offen offset:1024 sc1
    buffer_load_dwordx2 a[6:7], v5, s[28:31], s4 offen offset:1152 sc1
    s_add_u32 s4, s98, 0x27100
    buffer_load_dwordx2 a[8:9], v5, s[28:31], s4 offen offset:0 sc1
    buffer_load_dwordx2 a[10:11], v5, s[28:31], s4 offen offset:128 sc1
    buffer_load_dwordx2 a[12:13], v5, s[28:31], s4 offen offset:1024 sc1
    buffer_load_dwordx2 a[14:15], v5, s[28:31], s4 offen offset:1152 sc1
    s_add_u32 s4, s98, 0x4e200
    buffer_load_dwordx2 a[16:17], v5, s[28:31], s4 offen offset:0 sc1
    buffer_load_dwordx2 a[18:19], v5, s[28:31], s4 offen offset:128 sc1
    buffer_load_dwordx2 a[20:21], v5, s[28:31], s4 offen offset:1024 sc1
    buffer_load_dwordx2 a[22:23], v5, s[28:31], s4 offen offset:1152 sc1
    s_add_u32 s4, s98, 0x75300
    buffer_load_dwordx2 a[24:25], v5, s[28:31], s4 offen offset:0 sc1
    buffer_load_dwordx2 a[26:27], v5, s[28:31], s4 offen offset:128 sc1
    buffer_load_dwordx2 a[28:29], v5, s[28:31], s4 offen offset:1024 sc1
    buffer_load_dwordx2 a[30:31], v5, s[28:31], s4 offen offset:1152 sc1
    v_cvt_pk_bf16_f32 v87, v158, v159
    v_fma_f32 v160, v170, v152, -v160
    v_fma_f32 v161, v170, v153, -v161
    v_fma_f32 v162, v170, v154, -v162
    v_fma_f32 v163, v170, v155, -v163
    v_fma_f32 v164, v170, v156, -v164
    v_fma_f32 v165, v170, v157, -v165
    v_fma_f32 v166, v170, v158, -v166
    v_fma_f32 v167, v170, v159, -v167
    v_cvt_pk_bf16_f32 v92, v160, v161
    v_cvt_pk_bf16_f32 v93, v162, v163
    v_cvt_pk_bf16_f32 v94, v164, v165
    v_cvt_pk_bf16_f32 v95, v166, v167
    v_fma_f32 v152, v170, v160, -v152
    v_fma_f32 v153, v170, v161, -v153
    v_fma_f32 v154, v170, v162, -v154
    v_fma_f32 v155, v170, v163, -v155
    v_fma_f32 v156, v170, v164, -v156
    v_fma_f32 v157, v170, v165, -v157
    v_fma_f32 v158, v170, v166, -v158
    v_fma_f32 v159, v170, v167, -v159
    v_cvt_pk_bf16_f32 v100, v152, v153
    v_cvt_pk_bf16_f32 v101, v154, v155
    v_cvt_pk_bf16_f32 v102, v156, v157
    v_cvt_pk_bf16_f32 v103, v158, v159
    v_fma_f32 v160, v170, v152, -v160
    v_fma_f32 v161, v170, v153, -v161
    v_fma_f32 v162, v170, v154, -v162
    v_fma_f32 v163, v170, v155, -v163
    v_fma_f32 v164, v170, v156, -v164
    v_fma_f32 v165, v170, v157, -v165
    v_fma_f32 v166, v170, v158, -v166
    v_fma_f32 v167, v170, v159, -v167
    v_cvt_pk_bf16_f32 v108, v160, v161
    v_cvt_pk_bf16_f32 v109, v162, v163
    v_cvt_pk_bf16_f32 v110, v164, v165
    v_cvt_pk_bf16_f32 v111, v166, v167
    v_fma_f32 v152, v170, v160, -v152
    v_fma_f32 v153, v170, v161, -v153
    v_fma_f32 v154, v170, v162, -v154
    v_fma_f32 v155, v170, v163, -v155
    v_fma_f32 v156, v170, v164, -v156
    v_fma_f32 v157, v170, v165, -v157
    v_fma_f32 v158, v170, v166, -v158
    v_fma_f32 v159, v170, v167, -v159
    v_cvt_pk_bf16_f32 v116, v152, v153
    v_cvt_pk_bf16_f32 v117, v154, v155
    v_cvt_pk_bf16_f32 v118, v156, v157
    v_cvt_pk_bf16_f32 v119, v158, v159
    v_fma_f32 v160, v170, v152, -v160
    v_fma_f32 v161, v170, v153, -v161
    v_fma_f32 v162, v170, v154, -v162
    v_fma_f32 v163, v170, v155, -v163
    v_fma_f32 v164, v170, v156, -v164
    v_fma_f32 v165, v170, v157, -v165
    v_fma_f32 v166, v170, v158, -v166
    v_fma_f32 v167, v170, v159, -v167
    v_cvt_pk_bf16_f32 v124, v160, v161
    v_cvt_pk_bf16_f32 v125, v162, v163
    v_cvt_pk_bf16_f32 v126, v164, v165
    v_cvt_pk_bf16_f32 v127, v166, v167
    v_fma_f32 v152, v170, v160, -v152
    v_fma_f32 v153, v170, v161, -v153
    v_fma_f32 v154, v170, v162, -v154
    v_fma_f32 v155, v170, v163, -v155
    v_fma_f32 v156, v170, v164, -v156
    v_fma_f32 v157, v170, v165, -v157
    v_fma_f32 v158, v170, v166, -v158
    v_fma_f32 v159, v170, v167, -v159
    v_cvt_pk_bf16_f32 v132, v152, v153
    v_cvt_pk_bf16_f32 v133, v154, v155
    v_cvt_pk_bf16_f32 v134, v156, v157
    v_cvt_pk_bf16_f32 v135, v158, v159
    v_fma_f32 v160, v170, v152, -v160
    v_fma_f32 v161, v170, v153, -v161
    v_fma_f32 v162, v170, v154, -v162
    v_fma_f32 v163, v170, v155, -v163
    v_fma_f32 v164, v170, v156, -v164
    v_fma_f32 v165, v170, v157, -v165
    v_fma_f32 v166, v170, v158, -v166
    v_fma_f32 v167, v170, v159, -v167
    v_cvt_pk_bf16_f32 v140, v160, v161
    v_cvt_pk_bf16_f32 v141, v162, v163
    v_cvt_pk_bf16_f32 v142, v164, v165
    v_cvt_pk_bf16_f32 v143, v166, v167
    v_fma_f32 v152, v170, v160, -v152
    v_fma_f32 v153, v170, v161, -v153
    v_fma_f32 v154, v170, v162, -v154
    v_fma_f32 v155, v170, v163, -v155
    v_fma_f32 v156, v170, v164, -v156
    v_fma_f32 v157, v170, v165, -v157
    v_fma_f32 v158, v170, v166, -v158
    v_fma_f32 v159, v170, v167, -v159
    v_cvt_pk_bf16_f32 v148, v152, v153
    v_cvt_pk_bf16_f32 v149, v154, v155
    v_cvt_pk_bf16_f32 v150, v156, v157
    v_cvt_pk_bf16_f32 v151, v158, v159
    s_setprio 1
    s_lshl_b32 s4, s8, 13
    v_add_u32 v6, s4, v25
    v_mul_u32_u24 v7, 57344, v4
    v_add_u32 v7, v7, v18
    s_add_u32 s4, s53, 65536
    v_add_u32 v30, s4, v9
    s_waitcnt vmcnt(19)
    s_lshl_b32 s56, s8, 9
    v_lshl_add_u32 v7, v2, 3, s56
    ds_write_b64 v7, v[26:27] offset:30720
    v_add_u32 v30, s53, v9
    ds_write_b32 v19, v17 offset:192
    s_waitcnt vmcnt(12)
    v_mfma_f32_16x16x32_bf16 v[152:155], a[0:3], a[32:35], 0
    v_mfma_f32_16x16x32_bf16 v[168:171], a[0:3], a[48:51], 0
    v_mfma_f32_16x16x32_bf16 v[156:159], a[0:3], a[40:43], 0
    v_mfma_f32_16x16x32_bf16 v[172:175], a[0:3], a[56:59], 0
    v_mfma_f32_16x16x32_bf16 v[152:155], a[4:7], a[36:39], v[152:155]
    v_mfma_f32_16x16x32_bf16 v[168:171], a[4:7], a[52:55], v[168:171]
    v_mfma_f32_16x16x32_bf16 v[156:159], a[4:7], a[44:47], v[156:159]
    v_mfma_f32_16x16x32_bf16 v[172:175], a[4:7], a[60:63], v[172:175]
    s_waitcnt vmcnt(8)
    v_mfma_f32_16x16x32_bf16 v[160:163], a[8:11], a[32:35], 0
    s_nop 3
    v_cvt_pk_bf16_f32 v152, v152, v168
    v_cvt_pk_bf16_f32 v153, v153, v169
    v_mfma_f32_16x16x32_bf16 v[176:179], a[8:11], a[48:51], 0
    v_cvt_pk_bf16_f32 v154, v154, v170
    v_cvt_pk_bf16_f32 v155, v155, v171
    v_mfma_f32_16x16x32_bf16 v[164:167], a[8:11], a[40:43], 0
    ds_write_b128 v6, v[152:155] offset:0
    v_cvt_pk_bf16_f32 v156, v156, v172
    v_mfma_f32_16x16x32_bf16 v[180:183], a[8:11], a[56:59], 0
    v_cvt_pk_bf16_f32 v157, v157, v173
    v_cvt_pk_bf16_f32 v158, v158, v174
    v_mfma_f32_16x16x32_bf16 v[160:163], a[12:15], a[36:39], v[160:163]
    v_cvt_pk_bf16_f32 v159, v159, v175
    ds_write_b128 v6, v[156:159] offset:1024
    v_mfma_f32_16x16x32_bf16 v[176:179], a[12:15], a[52:55], v[176:179]
    v_mfma_f32_16x16x32_bf16 v[164:167], a[12:15], a[44:47], v[164:167]
    v_mfma_f32_16x16x32_bf16 v[180:183], a[12:15], a[60:63], v[180:183]
    s_waitcnt vmcnt(4)
    v_mfma_f32_16x16x32_bf16 v[152:155], a[16:19], a[32:35], 0
    s_nop 3
    v_cvt_pk_bf16_f32 v160, v160, v176
    v_cvt_pk_bf16_f32 v161, v161, v177
    v_mfma_f32_16x16x32_bf16 v[168:171], a[16:19], a[48:51], 0
    v_cvt_pk_bf16_f32 v162, v162, v178
    v_cvt_pk_bf16_f32 v163, v163, v179
    v_mfma_f32_16x16x32_bf16 v[156:159], a[16:19], a[40:43], 0
    ds_write_b128 v6, v[160:163] offset:2048
    v_cvt_pk_bf16_f32 v164, v164, v180
    v_mfma_f32_16x16x32_bf16 v[172:175], a[16:19], a[56:59], 0
    v_cvt_pk_bf16_f32 v165, v165, v181
    v_cvt_pk_bf16_f32 v166, v166, v182
    v_mfma_f32_16x16x32_bf16 v[152:155], a[20:23], a[36:39], v[152:155]
    v_cvt_pk_bf16_f32 v167, v167, v183
    ds_write_b128 v6, v[164:167] offset:3072
    v_mfma_f32_16x16x32_bf16 v[168:171], a[20:23], a[52:55], v[168:171]
    v_mfma_f32_16x16x32_bf16 v[156:159], a[20:23], a[44:47], v[156:159]
    v_mfma_f32_16x16x32_bf16 v[172:175], a[20:23], a[60:63], v[172:175]
    s_waitcnt vmcnt(0)
    v_mfma_f32_16x16x32_bf16 v[160:163], a[24:27], a[32:35], 0
    s_nop 3
    v_cvt_pk_bf16_f32 v152, v152, v168
    v_cvt_pk_bf16_f32 v153, v153, v169
    v_mfma_f32_16x16x32_bf16 v[176:179], a[24:27], a[48:51], 0
    v_cvt_pk_bf16_f32 v154, v154, v170
    v_cvt_pk_bf16_f32 v155, v155, v171
    v_mfma_f32_16x16x32_bf16 v[164:167], a[24:27], a[40:43], 0
    ds_write_b128 v6, v[152:155] offset:4096
    v_cvt_pk_bf16_f32 v156, v156, v172
    v_mfma_f32_16x16x32_bf16 v[180:183], a[24:27], a[56:59], 0
    v_cvt_pk_bf16_f32 v157, v157, v173
    v_cvt_pk_bf16_f32 v158, v158, v174
    v_mfma_f32_16x16x32_bf16 v[160:163], a[28:31], a[36:39], v[160:163]
    v_cvt_pk_bf16_f32 v159, v159, v175
    ds_write_b128 v6, v[156:159] offset:5120
    v_mfma_f32_16x16x32_bf16 v[176:179], a[28:31], a[52:55], v[176:179]
    v_mfma_f32_16x16x32_bf16 v[164:167], a[28:31], a[44:47], v[164:167]
    v_mfma_f32_16x16x32_bf16 v[180:183], a[28:31], a[60:63], v[180:183]
    s_nop 5
    v_cvt_pk_bf16_f32 v160, v160, v176
    v_cvt_pk_bf16_f32 v161, v161, v177
    v_cvt_pk_bf16_f32 v162, v162, v178
    v_cvt_pk_bf16_f32 v163, v163, v179
    ds_write_b128 v6, v[160:163] offset:6144
    v_cvt_pk_bf16_f32 v164, v164, v180
    v_cvt_pk_bf16_f32 v165, v165, v181
    v_cvt_pk_bf16_f32 v166, v166, v182
    v_cvt_pk_bf16_f32 v167, v167, v183
    ds_write_b128 v6, v[164:167] offset:7168
    ds_write_b32 v19, v17 offset:64
lw16:
    ds_read_b32 v8, v16 offset:64
    s_waitcnt lgkmcnt(0)
    v_cmp_ne_u32 vcc, 1, v8
    s_nop 1
    s_cbranch_vccnz lw16
    ds_read_b128 a[0:3], v25 offset:0
    ds_read_b128 a[4:7], v25 offset:1024
    ds_read_b128 a[8:11], v25 offset:2048
    ds_read_b128 a[12:15], v25 offset:3072
    ds_read_b128 a[16:19], v25 offset:4096
    ds_read_b128 a[20:23], v25 offset:5120
    ds_read_b128 a[24:27], v25 offset:6144
    ds_read_b128 a[28:31], v25 offset:7168
    ds_read_b128 a[32:35], v25 offset:8192
    ds_read_b128 a[36:39], v25 offset:9216
    ds_read_b128 a[40:43], v25 offset:10240
    ds_read_b128 a[44:47], v25 offset:11264
    ds_read_b128 a[48:51], v25 offset:12288
    ds_read_b128 a[52:55], v25 offset:13312
    s_waitcnt lgkmcnt(12)
    v_mfma_f32_16x16x32_bf16 v[168:171], v[32:35], a[0:3], 0
    ds_read_b128 a[56:59], v25 offset:14336
    v_mfma_f32_16x16x32_bf16 v[176:179], v[36:39], a[0:3], 0
    v_mfma_f32_16x16x32_bf16 v[172:175], v[32:35], a[4:7], 0
    ds_read_b128 a[60:63], v25 offset:15360
    v_mfma_f32_16x16x32_bf16 v[180:183], v[36:39], a[4:7], 0
    s_waitcnt lgkmcnt(12)
    v_mfma_f32_16x16x32_bf16 v[168:171], v[40:43], a[8:11], v[168:171]
    ds_read_b128 a[0:3], v25 offset:16384
    v_mfma_f32_16x16x32_bf16 v[176:179], v[44:47], a[8:11], v[176:179]
    v_mfma_f32_16x16x32_bf16 v[172:175], v[40:43], a[12:15], v[172:175]
    ds_read_b128 a[4:7], v25 offset:17408
    v_mfma_f32_16x16x32_bf16 v[180:183], v[44:47], a[12:15], v[180:183]
    s_waitcnt lgkmcnt(12)
    v_mfma_f32_16x16x32_bf16 v[168:171], v[48:51], a[16:19], v[168:171]
    ds_read_b128 a[8:11], v25 offset:18432
    v_mfma_f32_16x16x32_bf16 v[176:179], v[52:55], a[16:19], v[176:179]
    v_mfma_f32_16x16x32_bf16 v[172:175], v[48:51], a[20:23], v[172:175]
    ds_read_b128 a[12:15], v25 offset:19456
    v_mfma_f32_16x16x32_bf16 v[180:183], v[52:55], a[20:23], v[180:183]
    s_waitcnt lgkmcnt(12)
    v_mfma_f32_16x16x32_bf16 v[168:171], v[56:59], a[24:27], v[168:171]
    ds_read_b128 a[16:19], v25 offset:20480
    v_mfma_f32_16x16x32_bf16 v[176:179], v[60:63], a[24:27], v[176:179]
    v_mfma_f32_16x16x32_bf16 v[172:175], v[56:59], a[28:31], v[172:175]
    ds_read_b128 a[20:23], v25 offset:21504
    v_mfma_f32_16x16x32_bf16 v[180:183], v[60:63], a[28:31], v[180:183]
    s_waitcnt lgkmcnt(12)
    v_mfma_f32_16x16x32_bf16 v[168:171], v[64:67], a[32:35], v[168:171]
    ds_read_b128 a[24:27], v25 offset:22528
    v_mfma_f32_16x16x32_bf16 v[176:179], v[68:71], a[32:35], v[176:179]
    v_mfma_f32_16x16x32_bf16 v[172:175], v[64:67], a[36:39], v[172:175]
    ds_read_b128 a[28:31], v25 offset:23552
    v_mfma_f32_16x16x32_bf16 v[180:183], v[68:71], a[36:39], v[180:183]
    s_waitcnt lgkmcnt(12)
    v_mfma_f32_16x16x32_bf16 v[168:171], v[72:75], a[40:43], v[168:171]
    ds_read_b128 a[32:35], v25 offset:24576
    v_mfma_f32_16x16x32_bf16 v[176:179], v[76:79], a[40:43], v[176:179]
    v_mfma_f32_16x16x32_bf16 v[172:175], v[72:75], a[44:47], v[172:175]
    ds_read_b128 a[36:39], v25 offset:25600
    v_mfma_f32_16x16x32_bf16 v[180:183], v[76:79], a[44:47], v[180:183]
    s_waitcnt lgkmcnt(12)
    v_mfma_f32_16x16x32_bf16 v[168:171], v[80:83], a[48:51], v[168:171]
    ds_read_b128 a[40:43], v25 offset:26624
    v_mfma_f32_16x16x32_bf16 v[176:179], v[84:87], a[48:51], v[176:179]
    v_mfma_f32_16x16x32_bf16 v[172:175], v[80:83], a[52:55], v[172:175]
    ds_read_b128 a[44:47], v25 offset:27648
    v_mfma_f32_16x16x32_bf16 v[180:183], v[84:87], a[52:55], v[180:183]
    s_waitcnt lgkmcnt(12)
    v_mfma_f32_16x16x32_bf16 v[168:171], v[88:91], a[56:59], v[168:171]
    ds_read_b128 a[48:51], v25 offset:28672
    v_mfma_f32_16x16x32_bf16 v[176:179], v[92:95], a[56:59], v[176:179]
    v_mfma_f32_16x16x32_bf16 v[172:175], v[88:91], a[60:63], v[172:175]
    ds_read_b128 a[52:55], v25 offset:29696
    v_mfma_f32_16x16x32_bf16 v[180:183], v[92:95], a[60:63], v[180:183]
    s_waitcnt lgkmcnt(12)
    v_mfma_f32_16x16x32_bf16 v[168:171], v[96:99], a[0:3], v[168:171]
    v_mfma_f32_16x16x32_bf16 v[176:179], v[100:103], a[0:3], v[176:179]
    v_mfma_f32_16x16x32_bf16 v[172:175], v[96:99], a[4:7], v[172:175]
    v_mfma_f32_16x16x32_bf16 v[180:183], v[100:103], a[4:7], v[180:183]
    s_waitcnt lgkmcnt(10)
    v_mfma_f32_16x16x32_bf16 v[168:171], v[104:107], a[8:11], v[168:171]
    v_mfma_f32_16x16x32_bf16 v[176:179], v[108:111], a[8:11], v[176:179]
    v_mfma_f32_16x16x32_bf16 v[172:175], v[104:107], a[12:15], v[172:175]
    v_mfma_f32_16x16x32_bf16 v[180:183], v[108:111], a[12:15], v[180:183]
    s_waitcnt lgkmcnt(8)
    v_mfma_f32_16x16x32_bf16 v[168:171], v[112:115], a[16:19], v[168:171]
    v_mfma_f32_16x16x32_bf16 v[176:179], v[116:119], a[16:19], v[176:179]
    v_mfma_f32_16x16x32_bf16 v[172:175], v[112:115], a[20:23], v[172:175]
    v_mfma_f32_16x16x32_bf16 v[180:183], v[116:119], a[20:23], v[180:183]
    s_waitcnt lgkmcnt(6)
    v_mfma_f32_16x16x32_bf16 v[168:171], v[120:123], a[24:27], v[168:171]
    v_mfma_f32_16x16x32_bf16 v[176:179], v[124:127], a[24:27], v[176:179]
    v_mfma_f32_16x16x32_bf16 v[172:175], v[120:123], a[28:31], v[172:175]
    v_mfma_f32_16x16x32_bf16 v[180:183], v[124:127], a[28:31], v[180:183]
    s_waitcnt lgkmcnt(4)
    v_mfma_f32_16x16x32_bf16 v[168:171], v[128:131], a[32:35], v[168:171]
    v_mfma_f32_16x16x32_bf16 v[176:179], v[132:135], a[32:35], v[176:179]
    v_mfma_f32_16x16x32_bf16 v[172:175], v[128:131], a[36:39], v[172:175]
    v_mfma_f32_16x16x32_bf16 v[180:183], v[132:135], a[36:39], v[180:183]
    s_waitcnt lgkmcnt(2)
    v_mfma_f32_16x16x32_bf16 v[168:171], v[136:139], a[40:43], v[168:171]
    v_mfma_f32_16x16x32_bf16 v[176:179], v[140:143], a[40:43], v[176:179]
    v_mfma_f32_16x16x32_bf16 v[172:175], v[136:139], a[44:47], v[172:175]
    v_mfma_f32_16x16x32_bf16 v[180:183], v[140:143], a[44:47], v[180:183]
    s_waitcnt lgkmcnt(0)
    v_mfma_f32_16x16x32_bf16 v[168:171], v[144:147], a[48:51], v[168:171]
    v_mfma_f32_16x16x32_bf16 v[176:179], v[148:151], a[48:51], v[176:179]
    v_mfma_f32_16x16x32_bf16 v[172:175], v[144:147], a[52:55], v[172:175]
    v_mfma_f32_16x16x32_bf16 v[180:183], v[148:151], a[52:55], v[180:183]
    s_nop 4
    ds_write_b128 v30, v[168:171] offset:32768
    ds_write_b128 v30, v[176:179] offset:34816
    ds_write_b128 v30, v[172:175] offset:33792
    ds_write_b128 v30, v[180:183] offset:35840
    ds_write_b32 v19, v17 offset:176
    s_cmp_eq_u32 s8, 3
    s_cbranch_scc1 L_w3
    s_branch L_fin
L_w3:
    s_cmp_lg_u32 s2, 120
    s_cbranch_scc1 L_fin
    s_mov_b32 s4, 0x148f000
    s_add_u32 s5, s4, 0x120800
    s_mov_b32 s6, 0
sp17:
    s_load_dword s64, s[28:29], s4 offset:0 glc
    s_load_dword s65, s[28:29], s4 offset:590848 glc
    s_load_dword s66, s[28:29], s5 offset:0 glc
    s_load_dword s67, s[28:29], s5 offset:590848 glc
    s_add_u32 s6, s6, 1
    s_cmp_ge_u32 s6, 500000
    s_cbranch_scc1 spd17
    s_waitcnt lgkmcnt(0)
    s_xor_b32 s64, s64, s7
    s_xor_b32 s65, s65, s7
    s_or_b32 s64, s64, s65
    s_xor_b32 s66, s66, s7
    s_or_b32 s64, s64, s66
    s_xor_b32 s67, s67, s7
    s_or_b32 s64, s64, s67
    s_cbranch_scc1 sp17
spd17:
    s_waitcnt lgkmcnt(0)
    s_mov_b32 s3, 0x1910000
    buffer_store_dword v11, v10, s[28:31], s3 offen sc1
L_fin:
    s_endpgm
L_gate:
    s_nop 3
    v_mul_f32 v112, 0x3fb8aa3b, v112
    v_mul_f32 v113, 0x3fb8aa3b, v113
    v_mul_f32 v114, 0x3fb8aa3b, v114
    v_mul_f32 v115, 0x3fb8aa3b, v115
    v_exp_f32 v112, -v112
    v_exp_f32 v113, -v113
    v_exp_f32 v114, -v114
    v_exp_f32 v115, -v115
    v_add_f32 v112, 1.0, v112
    v_add_f32 v113, 1.0, v113
    v_add_f32 v114, 1.0, v114
    v_add_f32 v115, 1.0, v115
    v_rcp_f32 v112, v112
    v_rcp_f32 v113, v113
    v_rcp_f32 v114, v114
    v_rcp_f32 v115, v115
    v_mul_f32 v120, 0x3fb8aa3b, v120
    v_mul_f32 v121, 0x3fb8aa3b, v121
    v_mul_f32 v122, 0x3fb8aa3b, v122
    v_mul_f32 v123, 0x3fb8aa3b, v123
    v_exp_f32 v120, -v120
    v_exp_f32 v121, -v121
    v_exp_f32 v122, -v122
    v_exp_f32 v123, -v123
    v_add_f32 v120, 1.0, v120
    v_add_f32 v121, 1.0, v121
    v_add_f32 v122, 1.0, v122
    v_add_f32 v123, 1.0, v123
    v_rcp_f32 v120, v120
    v_rcp_f32 v121, v121
    v_rcp_f32 v122, v122
    v_rcp_f32 v123, v123
    s_nop 0
    s_branch L_a1st
L_end:
    s_endpgm
.section .rodata,"a"
.p2align 6
.amdhsa_kernel gated_mix__spectral_gfnet__dense_activation_mish__prompt_kernel
  .amdhsa_next_free_vgpr 256
  .amdhsa_next_free_sgpr 102
  .amdhsa_accum_offset 184
  .amdhsa_group_segment_fixed_size 0
  .amdhsa_kernarg_size 88
  .amdhsa_user_sgpr_count 2
  .amdhsa_user_sgpr_kernarg_segment_ptr 1
  .amdhsa_system_sgpr_workgroup_id_x 1
.end_amdhsa_kernel
```
